```python
import torch

def _softmax(x, axis=-1):
    return torch.softmax(x, dim=axis)
def _gelu(x):
    return torch.nn.functional.gelu(x, approximate="tanh")
def _silu(x):
    return torch.nn.functional.silu(x)
def _sigmoid(x):
    return torch.sigmoid(x)
def _layernorm(x, axis=-1, eps=1e-5):
    m = x.mean(dim=axis, keepdim=True)
    v = x.var(dim=axis, keepdim=True, unbiased=False)
    return (x - m) / torch.sqrt(v + eps)
def _scatter_add(tgt, idx, src, axis=0):
    return tgt.clone().index_add_(axis, idx, src)
def _segment_sum(src, seg, n):
    out = torch.zeros((n,) + src.shape[1:], dtype=src.dtype)
    return out.index_add_(0, seg, src)
def _pad(x, pw):
    flat = tuple(v for pair in reversed(pw) for v in pair)
    return torch.nn.functional.pad(x, flat)

kernel_name = 'gated_mix__sliding_block_cached__glu_gated_reglu__decode'

def setup_inputs():

    _w = (lambda a: (lambda t: t.to(torch.bfloat16) if t.is_floating_point() else t)(torch.as_tensor(a)))
    def _A_setup():
        B, Sq, D = 4, 1, 512
        Hq, Hkv, Sk, Dh = 32, 8, 16384, 128
        assert Hq % Hkv == 0, (Hq, Hkv)
        return {
            "x": _w((lambda *s: torch.randn(*s, dtype=torch.bfloat16) * 0.05)(B, Sq, D)),
            "k_cache": _w((lambda *s: torch.randn(*s, dtype=torch.bfloat16) * 3.2)(B, Hkv, Sk, Dh)),
            "v_cache": _w((lambda *s: torch.randn(*s, dtype=torch.bfloat16) * 0.05)(B, Hkv, Sk, Dh)),
            "wq": _w((lambda *s: torch.randn(*s, dtype=torch.bfloat16) * 3.2)(D, Hq * Dh) * (D ** -0.5)),
            "wo": _w((lambda *s: torch.randn(*s, dtype=torch.bfloat16) * 0.05)(Hq * Dh, D) * ((Hq * Dh) ** -0.5)),
        }
    _A_in = _A_setup()

    def _B_setup():
        B, S, D, F = 4, 1, 512, 1792
        return {
            "x": _w((lambda *s: torch.randn(*s, dtype=torch.bfloat16) * 0.05)(B, S, D)),
            "W_gate": _w((lambda *s: torch.randn(*s, dtype=torch.bfloat16) * 0.2)(D, F) * (2.0 / D) ** 0.5),
            "W_up": _w((lambda *s: torch.randn(*s, dtype=torch.bfloat16) * 0.2)(D, F) * (2.0 / D) ** 0.5),
            "W_down": _w((lambda *s: torch.randn(*s, dtype=torch.bfloat16) * 0.2)(F, D) * (1.0 / F) ** 0.5),
        }
    _B_in = _B_setup()

    return {
        "A_x": _A_in["x"],
        "A_k_cache": _A_in["k_cache"],
        "A_v_cache": _A_in["v_cache"],
        "A_wq": _A_in["wq"],
        "A_wo": _A_in["wo"],
        "B_x": _B_in["x"],
        "B_W_gate": _B_in["W_gate"],
        "B_W_up": _B_in["W_up"],
        "B_W_down": _B_in["W_down"],
        "gate_w": _w((lambda *s: torch.randn(*s, dtype=torch.bfloat16) * 0.05)(512) * 16.0),
    }

def reference(A_x, A_k_cache, A_v_cache, A_wq, A_wo, B_x, B_W_gate, B_W_up, B_W_down, gate_w):
    def _A_ref(x, k_cache, v_cache, wq, wo):
        B, Sq, D = x.shape
        Hq, Dh = 32, 128
        Hkv, Sk = k_cache.shape[1], k_cache.shape[2]
        W = min(4096, max(256, Sk // 4))
        rep = Hq // Hkv
        q = (lambda x, *d: x.permute(*d))((x @ wq).reshape(B, Sq, Hq, Dh), 0, 2, 1, 3)
        k = (lambda x, n, axis: torch.repeat_interleave(x, n, dim=axis))(k_cache[:, :, Sk - W:, :], rep, axis=1)
        v = (lambda x, n, axis: torch.repeat_interleave(x, n, dim=axis))(v_cache[:, :, Sk - W:, :], rep, axis=1)
        scores = torch.einsum("bhqd,bhkd->bhqk", q, k) * (Dh ** -0.5)
        p = _softmax(scores, axis=-1)
        o = torch.einsum("bhqk,bhkd->bhqd", p, v)
        return (lambda x, *d: x.permute(*d))(o, 0, 2, 1, 3).reshape(B, Sq, Hq * Dh) @ wo

    def _B_ref(x, W_gate, W_up, W_down):
        gate = torch.einsum("bsd,df->bsf", x, W_gate)
        up = torch.einsum("bsd,df->bsf", x, W_up)
        gate = gate * (lambda x, dt: x.to(dt))(gate > 0, gate.dtype)
        h = gate * up
        return torch.einsum("bsf,fd->bsd", h, W_down)

    x = A_x
    g = _sigmoid((x * gate_w).sum(-1, keepdims=True))
    a = _A_ref(x, A_k_cache, A_v_cache, A_wq, A_wo)
    b = _B_ref(x, B_W_gate, B_W_up, B_W_down)
    return g * a + (1 - g) * b
```

```asm
; @launch grid=(256,1,1) block=(512,1,1) lds=132160
.amdgcn_target "amdgcn-amd-amdhsa--gfx950"
.text
.globl gated_mix__sliding_block_cached__glu_gated_reglu__decode_kernel
.p2align 8
.type gated_mix__sliding_block_cached__glu_gated_reglu__decode_kernel,@function
gated_mix__sliding_block_cached__glu_gated_reglu__decode_kernel:
    s_cmp_ge_u32 s2, 256
    s_cbranch_scc1 L_end
    s_load_dwordx4 s[4:7], s[0:1], 0
    s_load_dwordx4 s[8:11], s[0:1], 16
    s_load_dwordx2 s[12:13], s[0:1], 32
    s_load_dwordx4 s[16:19], s[0:1], 48
    s_load_dwordx4 s[20:23], s[0:1], 64
    s_load_dwordx2 s[24:25], s[0:1], 80
    s_load_dwordx2 s[14:15], s[0:1], 96
    v_mov_b32 v250, v0
    v_and_b32 v251, 63, v0
    v_lshrrev_b32 v252, 6, v0
    v_lshrrev_b32 v253, 4, v251
    s_lshr_b32 s26, s2, 3
    s_and_b32 s27, s2, 7
    s_lshr_b32 s28, s2, 2
    s_and_b32 s29, s2, 3
    s_lshr_b32 s30, s2, 1
    s_mul_i32 s31, s30, 2341
    s_lshr_b32 s31, s31, 16
    s_mul_i32 s32, s31, 28
    s_sub_u32 s30, s30, s32
    s_and_b32 s33, s2, 1
    s_min_u32 s38, s31, 3
    v_lshrrev_b32 v204, 3, v251
    v_lshl_add_u32 v204, v252, 4, v204
    v_and_b32 v205, 7, v251
    v_lshlrev_b32 v205, 4, v205
    s_waitcnt lgkmcnt(0)
    v_mov_b32 v206, 0
    global_load_dword v254, v206, s[14:15] sc1
    s_lshl_b32 s34, s29, 8
    v_lshl_add_u32 v206, v204, 1, s34
    global_load_ushort v144, v206, s[4:5] offset:0
    global_load_ushort v145, v206, s[4:5] offset:1024
    global_load_ushort v146, v206, s[4:5] offset:2048
    global_load_ushort v147, v206, s[4:5] offset:3072
    global_load_ushort v148, v206, s[4:5] offset:16
    global_load_ushort v149, v206, s[4:5] offset:1040
    global_load_ushort v150, v206, s[4:5] offset:2064
    global_load_ushort v151, v206, s[4:5] offset:3088
    s_lshl_b32 s34, s38, 8
    v_lshl_add_u32 v206, v204, 1, s34
    global_load_ushort v152, v206, s[4:5] offset:0
    global_load_ushort v153, v206, s[4:5] offset:1024
    global_load_ushort v154, v206, s[4:5] offset:2048
    global_load_ushort v155, v206, s[4:5] offset:3072
    global_load_ushort v156, v206, s[4:5] offset:16
    global_load_ushort v157, v206, s[4:5] offset:1040
    global_load_ushort v158, v206, s[4:5] offset:2064
    global_load_ushort v159, v206, s[4:5] offset:3088
    s_lshl_b32 s34, s29, 20
    s_lshl_b32 s35, s28, 7
    s_add_u32 s34, s34, s35
    v_lshlrev_b32 v206, 13, v204
    v_add3_u32 v206, v206, v205, s34
    global_load_dwordx4 v[80:83], v206, s[10:11] nt
    v_add_u32 v206, 0x10000, v206
    global_load_dwordx4 v[84:87], v206, s[10:11] nt
    s_cmp_eq_u32 s33, 0
    s_cselect_b32 s36, s16, s18
    s_cselect_b32 s37, s17, s19
    s_min_u32 s38, s31, 3
    s_mul_i32 s34, s38, 128*3584
    s_lshl_b32 s35, s30, 7
    s_add_u32 s34, s34, s35
    s_movk_i32 s35, 3584
    v_mul_lo_u32 v206, v204, s35
    v_add3_u32 v206, v206, v205, s34
    global_load_dwordx4 v[88:91], v206, s[36:37] nt
    v_add_u32 v206, 28672, v206
    global_load_dwordx4 v[92:95], v206, s[36:37] nt
    s_lshl_b32 s34, s26, 22
    s_lshl_b32 s35, s27, 17
    s_add_u32 s34, s34, s35
    s_add_u32 s34, s34, 0x300000
    s_add_u32 s6, s6, s34
    s_addc_u32 s7, s7, 0
    s_add_u32 s8, s8, s34
    s_addc_u32 s9, s9, 0
    v_and_b32 v206, 15, v251
    v_lshlrev_b32 v206, 8, v206
    v_lshl_add_u32 v206, v253, 4, v206
    v_lshl_add_u32 v206, v252, 12, v206
    global_load_dwordx4 v[16:19], v206, s[6:7] offset:0 nt
    global_load_dwordx4 v[20:23], v206, s[6:7] offset:64 nt
    global_load_dwordx4 v[24:27], v206, s[6:7] offset:128 nt
    global_load_dwordx4 v[28:31], v206, s[6:7] offset:192 nt
    v_add_u32 v206, 0x8000, v206
    global_load_dwordx4 v[32:35], v206, s[6:7] offset:0 nt
    global_load_dwordx4 v[36:39], v206, s[6:7] offset:64 nt
    global_load_dwordx4 v[40:43], v206, s[6:7] offset:128 nt
    global_load_dwordx4 v[44:47], v206, s[6:7] offset:192 nt
    v_add_u32 v206, 0x8000, v206
    global_load_dwordx4 v[48:51], v206, s[6:7] offset:0 nt
    global_load_dwordx4 v[52:55], v206, s[6:7] offset:64 nt
    global_load_dwordx4 v[56:59], v206, s[6:7] offset:128 nt
    global_load_dwordx4 v[60:63], v206, s[6:7] offset:192 nt
    v_add_u32 v206, 0x8000, v206
    global_load_dwordx4 v[64:67], v206, s[6:7] offset:0 nt
    global_load_dwordx4 v[68:71], v206, s[6:7] offset:64 nt
    global_load_dwordx4 v[72:75], v206, s[6:7] offset:128 nt
    global_load_dwordx4 v[76:79], v206, s[6:7] offset:192 nt
    s_waitcnt vmcnt(16)
    v_add_u32 v254, 1, v254
    v_lshlrev_b32 v144, 16, v144
    v_lshlrev_b32 v145, 16, v145
    v_lshlrev_b32 v146, 16, v146
    v_lshlrev_b32 v147, 16, v147
    v_lshlrev_b32 v148, 16, v148
    v_lshlrev_b32 v149, 16, v149
    v_lshlrev_b32 v150, 16, v150
    v_lshlrev_b32 v151, 16, v151
    v_lshlrev_b32 v152, 16, v152
    v_lshlrev_b32 v153, 16, v153
    v_lshlrev_b32 v154, 16, v154
    v_lshlrev_b32 v155, 16, v155
    v_lshlrev_b32 v156, 16, v156
    v_lshlrev_b32 v157, 16, v157
    v_lshlrev_b32 v158, 16, v158
    v_lshlrev_b32 v159, 16, v159
    v_lshlrev_b32 v196, 16, v80
    v_and_b32 v197, 0xffff0000, v80
    v_lshlrev_b32 v198, 16, v81
    v_and_b32 v199, 0xffff0000, v81
    v_lshlrev_b32 v200, 16, v82
    v_and_b32 v201, 0xffff0000, v82
    v_lshlrev_b32 v202, 16, v83
    v_and_b32 v203, 0xffff0000, v83
    v_mul_f32 v164, v144, v196
    v_mul_f32 v165, v144, v197
    v_mul_f32 v166, v144, v198
    v_mul_f32 v167, v144, v199
    v_mul_f32 v168, v144, v200
    v_mul_f32 v169, v144, v201
    v_mul_f32 v170, v144, v202
    v_mul_f32 v171, v144, v203
    v_mul_f32 v172, v145, v196
    v_mul_f32 v173, v145, v197
    v_mul_f32 v174, v145, v198
    v_mul_f32 v175, v145, v199
    v_mul_f32 v176, v145, v200
    v_mul_f32 v177, v145, v201
    v_mul_f32 v178, v145, v202
    v_mul_f32 v179, v145, v203
    v_mul_f32 v180, v146, v196
    v_mul_f32 v181, v146, v197
    v_mul_f32 v182, v146, v198
    v_mul_f32 v183, v146, v199
    v_mul_f32 v184, v146, v200
    v_mul_f32 v185, v146, v201
    v_mul_f32 v186, v146, v202
    v_mul_f32 v187, v146, v203
    v_mul_f32 v188, v147, v196
    v_mul_f32 v189, v147, v197
    v_mul_f32 v190, v147, v198
    v_mul_f32 v191, v147, v199
    v_mul_f32 v192, v147, v200
    v_mul_f32 v193, v147, v201
    v_mul_f32 v194, v147, v202
    v_mul_f32 v195, v147, v203
    v_lshlrev_b32 v196, 16, v84
    v_and_b32 v197, 0xffff0000, v84
    v_lshlrev_b32 v198, 16, v85
    v_and_b32 v199, 0xffff0000, v85
    v_lshlrev_b32 v200, 16, v86
    v_and_b32 v201, 0xffff0000, v86
    v_lshlrev_b32 v202, 16, v87
    v_and_b32 v203, 0xffff0000, v87
    v_fmac_f32 v164, v148, v196
    v_fmac_f32 v165, v148, v197
    v_fmac_f32 v166, v148, v198
    v_fmac_f32 v167, v148, v199
    v_fmac_f32 v168, v148, v200
    v_fmac_f32 v169, v148, v201
    v_fmac_f32 v170, v148, v202
    v_fmac_f32 v171, v148, v203
    v_fmac_f32 v172, v149, v196
    v_fmac_f32 v173, v149, v197
    v_fmac_f32 v174, v149, v198
    v_fmac_f32 v175, v149, v199
    v_fmac_f32 v176, v149, v200
    v_fmac_f32 v177, v149, v201
    v_fmac_f32 v178, v149, v202
    v_fmac_f32 v179, v149, v203
    v_fmac_f32 v180, v150, v196
    v_fmac_f32 v181, v150, v197
    v_fmac_f32 v182, v150, v198
    v_fmac_f32 v183, v150, v199
    v_fmac_f32 v184, v150, v200
    v_fmac_f32 v185, v150, v201
    v_fmac_f32 v186, v150, v202
    v_fmac_f32 v187, v150, v203
    v_fmac_f32 v188, v151, v196
    v_fmac_f32 v189, v151, v197
    v_fmac_f32 v190, v151, v198
    v_fmac_f32 v191, v151, v199
    v_fmac_f32 v192, v151, v200
    v_fmac_f32 v193, v151, v201
    v_fmac_f32 v194, v151, v202
    v_fmac_f32 v195, v151, v203
    v_lshrrev_b32 v206, 3, v250
    v_lshlrev_b32 v206, 10, v206
    v_lshl_add_u32 v206, v205, 1, v206
    ds_write_b128 v206, v[164:167] offset:0
    ds_write_b128 v206, v[168:171] offset:16
    ds_write_b128 v206, v[172:175] offset:256
    ds_write_b128 v206, v[176:179] offset:272
    ds_write_b128 v206, v[180:183] offset:512
    ds_write_b128 v206, v[184:187] offset:528
    ds_write_b128 v206, v[188:191] offset:768
    ds_write_b128 v206, v[192:195] offset:784
    s_waitcnt lgkmcnt(0)
    v_lshlrev_b32 v196, 16, v88
    v_and_b32 v197, 0xffff0000, v88
    v_lshlrev_b32 v198, 16, v89
    v_and_b32 v199, 0xffff0000, v89
    v_lshlrev_b32 v200, 16, v90
    v_and_b32 v201, 0xffff0000, v90
    v_lshlrev_b32 v202, 16, v91
    v_and_b32 v203, 0xffff0000, v91
    v_mul_f32 v164, v152, v196
    v_mul_f32 v165, v152, v197
    v_mul_f32 v166, v152, v198
    v_mul_f32 v167, v152, v199
    v_mul_f32 v168, v152, v200
    v_mul_f32 v169, v152, v201
    v_mul_f32 v170, v152, v202
    v_mul_f32 v171, v152, v203
    v_mul_f32 v172, v153, v196
    v_mul_f32 v173, v153, v197
    v_mul_f32 v174, v153, v198
    v_mul_f32 v175, v153, v199
    v_mul_f32 v176, v153, v200
    v_mul_f32 v177, v153, v201
    v_mul_f32 v178, v153, v202
    v_mul_f32 v179, v153, v203
    v_mul_f32 v180, v154, v196
    v_mul_f32 v181, v154, v197
    v_mul_f32 v182, v154, v198
    v_mul_f32 v183, v154, v199
    v_mul_f32 v184, v154, v200
    v_mul_f32 v185, v154, v201
    v_mul_f32 v186, v154, v202
    v_mul_f32 v187, v154, v203
    v_mul_f32 v188, v155, v196
    v_mul_f32 v189, v155, v197
    v_mul_f32 v190, v155, v198
    v_mul_f32 v191, v155, v199
    v_mul_f32 v192, v155, v200
    v_mul_f32 v193, v155, v201
    v_mul_f32 v194, v155, v202
    v_mul_f32 v195, v155, v203
    v_lshlrev_b32 v196, 16, v92
    v_and_b32 v197, 0xffff0000, v92
    v_lshlrev_b32 v198, 16, v93
    v_and_b32 v199, 0xffff0000, v93
    v_lshlrev_b32 v200, 16, v94
    v_and_b32 v201, 0xffff0000, v94
    v_lshlrev_b32 v202, 16, v95
    v_and_b32 v203, 0xffff0000, v95
    v_fmac_f32 v164, v156, v196
    v_fmac_f32 v165, v156, v197
    v_fmac_f32 v166, v156, v198
    v_fmac_f32 v167, v156, v199
    v_fmac_f32 v168, v156, v200
    v_fmac_f32 v169, v156, v201
    v_fmac_f32 v170, v156, v202
    v_fmac_f32 v171, v156, v203
    v_fmac_f32 v172, v157, v196
    v_fmac_f32 v173, v157, v197
    v_fmac_f32 v174, v157, v198
    v_fmac_f32 v175, v157, v199
    v_fmac_f32 v176, v157, v200
    v_fmac_f32 v177, v157, v201
    v_fmac_f32 v178, v157, v202
    v_fmac_f32 v179, v157, v203
    v_fmac_f32 v180, v158, v196
    v_fmac_f32 v181, v158, v197
    v_fmac_f32 v182, v158, v198
    v_fmac_f32 v183, v158, v199
    v_fmac_f32 v184, v158, v200
    v_fmac_f32 v185, v158, v201
    v_fmac_f32 v186, v158, v202
    v_fmac_f32 v187, v158, v203
    v_fmac_f32 v188, v159, v196
    v_fmac_f32 v189, v159, v197
    v_fmac_f32 v190, v159, v198
    v_fmac_f32 v191, v159, v199
    v_fmac_f32 v192, v159, v200
    v_fmac_f32 v193, v159, v201
    v_fmac_f32 v194, v159, v202
    v_fmac_f32 v195, v159, v203
    v_add_u32 v206, 0x10000, v206
    ds_write_b128 v206, v[164:167] offset:0
    ds_write_b128 v206, v[168:171] offset:16
    ds_write_b128 v206, v[172:175] offset:256
    ds_write_b128 v206, v[176:179] offset:272
    ds_write_b128 v206, v[180:183] offset:512
    ds_write_b128 v206, v[184:187] offset:528
    ds_write_b128 v206, v[188:191] offset:768
    ds_write_b128 v206, v[192:195] offset:784
    s_waitcnt lgkmcnt(0)
    s_barrier
    v_lshrrev_b32 v206, 8, v250
    v_lshlrev_b32 v206, 16, v206
    v_and_b32 v207, 255, v250
    v_lshl_add_u32 v206, v207, 2, v206
    ds_read_b32 v144, v206 offset:0
    ds_read_b32 v145, v206 offset:1024
    ds_read_b32 v146, v206 offset:2048
    ds_read_b32 v147, v206 offset:3072
    ds_read_b32 v148, v206 offset:4096
    ds_read_b32 v149, v206 offset:5120
    ds_read_b32 v150, v206 offset:6144
    ds_read_b32 v151, v206 offset:7168
    s_waitcnt lgkmcnt(0)
    v_mov_b32 v208, v144
    v_add_f32 v208, v208, v145
    v_add_f32 v208, v208, v146
    v_add_f32 v208, v208, v147
    v_add_f32 v208, v208, v148
    v_add_f32 v208, v208, v149
    v_add_f32 v208, v208, v150
    v_add_f32 v208, v208, v151
    ds_read_b32 v144, v206 offset:8192
    ds_read_b32 v145, v206 offset:9216
    ds_read_b32 v146, v206 offset:10240
    ds_read_b32 v147, v206 offset:11264
    ds_read_b32 v148, v206 offset:12288
    ds_read_b32 v149, v206 offset:13312
    ds_read_b32 v150, v206 offset:14336
    ds_read_b32 v151, v206 offset:15360
    s_waitcnt lgkmcnt(0)
    v_add_f32 v208, v208, v144
    v_add_f32 v208, v208, v145
    v_add_f32 v208, v208, v146
    v_add_f32 v208, v208, v147
    v_add_f32 v208, v208, v148
    v_add_f32 v208, v208, v149
    v_add_f32 v208, v208, v150
    v_add_f32 v208, v208, v151
    ds_read_b32 v144, v206 offset:16384
    ds_read_b32 v145, v206 offset:17408
    ds_read_b32 v146, v206 offset:18432
    ds_read_b32 v147, v206 offset:19456
    ds_read_b32 v148, v206 offset:20480
    ds_read_b32 v149, v206 offset:21504
    ds_read_b32 v150, v206 offset:22528
    ds_read_b32 v151, v206 offset:23552
    s_waitcnt lgkmcnt(0)
    v_add_f32 v208, v208, v144
    v_add_f32 v208, v208, v145
    v_add_f32 v208, v208, v146
    v_add_f32 v208, v208, v147
    v_add_f32 v208, v208, v148
    v_add_f32 v208, v208, v149
    v_add_f32 v208, v208, v150
    v_add_f32 v208, v208, v151
    ds_read_b32 v144, v206 offset:24576
    ds_read_b32 v145, v206 offset:25600
    ds_read_b32 v146, v206 offset:26624
    ds_read_b32 v147, v206 offset:27648
    ds_read_b32 v148, v206 offset:28672
    ds_read_b32 v149, v206 offset:29696
    ds_read_b32 v150, v206 offset:30720
    ds_read_b32 v151, v206 offset:31744
    s_waitcnt lgkmcnt(0)
    v_add_f32 v208, v208, v144
    v_add_f32 v208, v208, v145
    v_add_f32 v208, v208, v146
    v_add_f32 v208, v208, v147
    v_add_f32 v208, v208, v148
    v_add_f32 v208, v208, v149
    v_add_f32 v208, v208, v150
    v_add_f32 v208, v208, v151
    ds_read_b32 v144, v206 offset:32768
    ds_read_b32 v145, v206 offset:33792
    ds_read_b32 v146, v206 offset:34816
    ds_read_b32 v147, v206 offset:35840
    ds_read_b32 v148, v206 offset:36864
    ds_read_b32 v149, v206 offset:37888
    ds_read_b32 v150, v206 offset:38912
    ds_read_b32 v151, v206 offset:39936
    s_waitcnt lgkmcnt(0)
    v_add_f32 v208, v208, v144
    v_add_f32 v208, v208, v145
    v_add_f32 v208, v208, v146
    v_add_f32 v208, v208, v147
    v_add_f32 v208, v208, v148
    v_add_f32 v208, v208, v149
    v_add_f32 v208, v208, v150
    v_add_f32 v208, v208, v151
    ds_read_b32 v144, v206 offset:40960
    ds_read_b32 v145, v206 offset:41984
    ds_read_b32 v146, v206 offset:43008
    ds_read_b32 v147, v206 offset:44032
    ds_read_b32 v148, v206 offset:45056
    ds_read_b32 v149, v206 offset:46080
    ds_read_b32 v150, v206 offset:47104
    ds_read_b32 v151, v206 offset:48128
    s_waitcnt lgkmcnt(0)
    v_add_f32 v208, v208, v144
    v_add_f32 v208, v208, v145
    v_add_f32 v208, v208, v146
    v_add_f32 v208, v208, v147
    v_add_f32 v208, v208, v148
    v_add_f32 v208, v208, v149
    v_add_f32 v208, v208, v150
    v_add_f32 v208, v208, v151
    ds_read_b32 v144, v206 offset:49152
    ds_read_b32 v145, v206 offset:50176
    ds_read_b32 v146, v206 offset:51200
    ds_read_b32 v147, v206 offset:52224
    ds_read_b32 v148, v206 offset:53248
    ds_read_b32 v149, v206 offset:54272
    ds_read_b32 v150, v206 offset:55296
    ds_read_b32 v151, v206 offset:56320
    s_waitcnt lgkmcnt(0)
    v_add_f32 v208, v208, v144
    v_add_f32 v208, v208, v145
    v_add_f32 v208, v208, v146
    v_add_f32 v208, v208, v147
    v_add_f32 v208, v208, v148
    v_add_f32 v208, v208, v149
    v_add_f32 v208, v208, v150
    v_add_f32 v208, v208, v151
    ds_read_b32 v144, v206 offset:57344
    ds_read_b32 v145, v206 offset:58368
    ds_read_b32 v146, v206 offset:59392
    ds_read_b32 v147, v206 offset:60416
    ds_read_b32 v148, v206 offset:61440
    ds_read_b32 v149, v206 offset:62464
    ds_read_b32 v150, v206 offset:63488
    ds_read_b32 v151, v206 offset:64512
    s_waitcnt lgkmcnt(0)
    v_add_f32 v208, v208, v144
    v_add_f32 v208, v208, v145
    v_add_f32 v208, v208, v146
    v_add_f32 v208, v208, v147
    v_add_f32 v208, v208, v148
    v_add_f32 v208, v208, v149
    v_add_f32 v208, v208, v150
    v_add_f32 v208, v208, v151
    v_mov_b32 v209, v254
    s_lshl_b32 s34, s29, 17
    s_lshl_b32 s35, s28, 9
    s_add_u32 s34, s34, s35
    s_add_u32 s34, s34, 4096
    v_lshrrev_b32 v210, 6, v207
    v_and_b32 v211, 63, v250
    v_lshlrev_b32 v212, 15, v210
    v_lshl_add_u32 v212, v211, 3, v212
    v_add_u32 v212, s34, v212
    s_lshl_b32 s35, s33, 2
    s_add_u32 s35, s35, s31
    s_mul_i32 s35, s35, 4*1792*8
    s_lshl_b32 s34, s30, 9
    s_add_u32 s35, s35, s34
    s_add_u32 s35, s35, 528384
    s_movk_i32 s34, 1792*8
    v_mul_lo_u32 v213, v210, s34
    v_lshl_add_u32 v213, v211, 3, v213
    v_add_u32 v213, s35, v213
    v_cmp_gt_u32 vcc, 256, v250
    s_nop 1
    v_cndmask_b32 v212, v213, v212, vcc
    s_cmp_lt_u32 s2, 224
    s_cselect_b64 s[42:43], -1, vcc
    s_and_saveexec_b64 s[44:45], s[42:43]
    global_store_dwordx2 v212, v[208:209], s[14:15] sc1
    s_or_b64 exec, exec, s[44:45]
    s_lshr_b32 s34, s26, 3
    s_and_b32 s35, s26, 7
    s_lshl_b32 s34, s34, 15
    s_lshl_b32 s35, s35, 12
    s_add_u32 s34, s34, s35
    s_add_u32 s34, s34, 4096
    v_lshl_add_u32 v206, v250, 3, s34
    s_mov_b32 s40, 0
L_spin0:
    global_load_dwordx2 v[144:145], v206, s[14:15] sc1
    v_add_u32 v206, 0x20000, v206
    global_load_dwordx2 v[146:147], v206, s[14:15] sc1
    v_add_u32 v206, 0x20000, v206
    global_load_dwordx2 v[148:149], v206, s[14:15] sc1
    v_add_u32 v206, 0x20000, v206
    global_load_dwordx2 v[150:151], v206, s[14:15] sc1
    v_subrev_u32 v206, 0x60000, v206
    s_waitcnt vmcnt(0)
    v_xor_b32 v207, v145, v254
    v_xor_b32 v208, v147, v254
    v_or_b32 v207, v207, v208
    v_xor_b32 v208, v149, v254
    v_or_b32 v207, v207, v208
    v_xor_b32 v208, v151, v254
    v_or_b32 v207, v207, v208
    v_cmp_ne_u32 vcc, 0, v207
    s_cbranch_vccz L_spind0
    s_sleep 1
    s_add_u32 s40, s40, 1
    s_cmp_lt_u32 s40, 200000
    s_cbranch_scc1 L_spin0
L_spind0:
    v_add_f32 v144, v144, v146
    v_add_f32 v148, v148, v150
    v_add_f32 v144, v144, v148
    v_cvt_pk_bf16_f32 v144, v144, v144
    v_lshlrev_b32 v206, 1, v250
    v_add_u32 v206, 131072, v206
    ds_write_b16 v206, v144
    s_waitcnt lgkmcnt(0)
    s_barrier
    v_and_b32 v206, 3, v251
    v_lshlrev_b32 v206, 8, v206
    v_lshl_add_u32 v206, v253, 4, v206
    v_add_u32 v206, 131072, v206
    ds_read_b128 v[0:3], v206 offset:0
    ds_read_b128 v[4:7], v206 offset:64
    ds_read_b128 v[8:11], v206 offset:128
    ds_read_b128 v[12:15], v206 offset:192
    v_and_b32 v207, 15, v251
    v_lshlrev_b32 v207, 4, v207
    v_lshl_add_u32 v207, v253, 15, v207
    v_lshl_add_u32 v207, v252, 12, v207
    global_load_dwordx4 v[80:83], v207, s[8:9] offset:0 nt
    global_load_dwordx4 v[84:87], v207, s[8:9] offset:256 nt
    global_load_dwordx4 v[88:91], v207, s[8:9] offset:512 nt
    global_load_dwordx4 v[92:95], v207, s[8:9] offset:768 nt
    global_load_dwordx4 v[96:99], v207, s[8:9] offset:1024 nt
    global_load_dwordx4 v[100:103], v207, s[8:9] offset:1280 nt
    global_load_dwordx4 v[104:107], v207, s[8:9] offset:1536 nt
    global_load_dwordx4 v[108:111], v207, s[8:9] offset:1792 nt
    global_load_dwordx4 v[112:115], v207, s[8:9] offset:2048 nt
    global_load_dwordx4 v[116:119], v207, s[8:9] offset:2304 nt
    global_load_dwordx4 v[120:123], v207, s[8:9] offset:2560 nt
    global_load_dwordx4 v[124:127], v207, s[8:9] offset:2816 nt
    global_load_dwordx4 v[128:131], v207, s[8:9] offset:3072 nt
    global_load_dwordx4 v[132:135], v207, s[8:9] offset:3328 nt
    global_load_dwordx4 v[136:139], v207, s[8:9] offset:3584 nt
    global_load_dwordx4 v[140:143], v207, s[8:9] offset:3840 nt
    s_lshl_b32 s34, s26, 17
    s_lshl_b32 s35, s27, 7
    s_add_u32 s34, s34, s35
    v_lshlrev_b32 v207, 10, v204
    v_add3_u32 v207, v207, v205, s34
    global_load_dwordx4 v[232:235], v207, s[12:13] nt
    v_add_u32 v207, 0x2000, v207
    global_load_dwordx4 v[236:239], v207, s[12:13] nt
    s_min_u32 s34, s26, 13
    s_lshl_b32 s34, s34, 17
    s_add_u32 s34, s34, s35
    v_lshlrev_b32 v207, 10, v204
    v_add3_u32 v207, v207, v205, s34
    global_load_dwordx4 v[224:227], v207, s[20:21] nt
    v_add_u32 v207, 0x2000, v207
    global_load_dwordx4 v[228:231], v207, s[20:21] nt
    s_mov_b32 s46, 0xffff0000
    s_mov_b32 s47, 0
    s_mov_b32 s48, 0
    s_mov_b32 s49, 0xffff
    s_mov_b32 s50, 0
    s_mov_b32 s51, 0xffff0000
    s_waitcnt lgkmcnt(0)
    v_mfma_f32_16x16x32_bf16 v[144:147], v[0:3], v[16:19], 0
    v_mfma_f32_16x16x32_bf16 v[144:147], v[4:7], v[20:23], v[144:147]
    v_mfma_f32_16x16x32_bf16 v[144:147], v[8:11], v[24:27], v[144:147]
    v_mfma_f32_16x16x32_bf16 v[144:147], v[12:15], v[28:31], v[144:147]
    v_mfma_f32_16x16x32_bf16 v[148:151], v[0:3], v[32:35], 0
    v_mfma_f32_16x16x32_bf16 v[148:151], v[4:7], v[36:39], v[148:151]
    v_mfma_f32_16x16x32_bf16 v[148:151], v[8:11], v[40:43], v[148:151]
    v_mfma_f32_16x16x32_bf16 v[148:151], v[12:15], v[44:47], v[148:151]
    v_mfma_f32_16x16x32_bf16 v[152:155], v[0:3], v[48:51], 0
    v_mfma_f32_16x16x32_bf16 v[152:155], v[4:7], v[52:55], v[152:155]
    v_mfma_f32_16x16x32_bf16 v[152:155], v[8:11], v[56:59], v[152:155]
    v_mfma_f32_16x16x32_bf16 v[152:155], v[12:15], v[60:63], v[152:155]
    v_mfma_f32_16x16x32_bf16 v[156:159], v[0:3], v[64:67], 0
    v_mfma_f32_16x16x32_bf16 v[156:159], v[4:7], v[68:71], v[156:159]
    v_mfma_f32_16x16x32_bf16 v[156:159], v[8:11], v[72:75], v[156:159]
    v_mfma_f32_16x16x32_bf16 v[156:159], v[12:15], v[76:79], v[156:159]
    s_nop 7
    s_nop 1
    v_cndmask_b32 v160, v144, v148, s[46:47]
    v_cndmask_b32 v161, v145, v149, s[46:47]
    v_cndmask_b32 v162, v146, v150, s[46:47]
    v_cndmask_b32 v163, v147, v151, s[46:47]
    v_cndmask_b32 v160, v160, v152, s[48:49]
    v_cndmask_b32 v161, v161, v153, s[48:49]
    v_cndmask_b32 v162, v162, v154, s[48:49]
    v_cndmask_b32 v163, v163, v155, s[48:49]
    v_cndmask_b32 v160, v160, v156, s[50:51]
    v_cndmask_b32 v161, v161, v157, s[50:51]
    v_cndmask_b32 v162, v162, v158, s[50:51]
    v_cndmask_b32 v163, v163, v159, s[50:51]
    v_mov_b32 v144, v160
    v_mov_b32 v145, v161
    v_mov_b32 v146, v162
    v_mov_b32 v147, v163
    s_nop 1
    v_max_f32_dpp v144, v144, v144 quad_perm:[1,0,3,2] row_mask:0xf bank_mask:0xf
    v_max_f32_dpp v145, v145, v145 quad_perm:[1,0,3,2] row_mask:0xf bank_mask:0xf
    v_max_f32_dpp v146, v146, v146 quad_perm:[1,0,3,2] row_mask:0xf bank_mask:0xf
    v_max_f32_dpp v147, v147, v147 quad_perm:[1,0,3,2] row_mask:0xf bank_mask:0xf
    v_max_f32_dpp v144, v144, v144 quad_perm:[2,3,0,1] row_mask:0xf bank_mask:0xf
    v_max_f32_dpp v145, v145, v145 quad_perm:[2,3,0,1] row_mask:0xf bank_mask:0xf
    v_max_f32_dpp v146, v146, v146 quad_perm:[2,3,0,1] row_mask:0xf bank_mask:0xf
    v_max_f32_dpp v147, v147, v147 quad_perm:[2,3,0,1] row_mask:0xf bank_mask:0xf
    v_max_f32_dpp v144, v144, v144 row_half_mirror row_mask:0xf bank_mask:0xf
    v_max_f32_dpp v145, v145, v145 row_half_mirror row_mask:0xf bank_mask:0xf
    v_max_f32_dpp v146, v146, v146 row_half_mirror row_mask:0xf bank_mask:0xf
    v_max_f32_dpp v147, v147, v147 row_half_mirror row_mask:0xf bank_mask:0xf
    v_max_f32_dpp v144, v144, v144 row_mirror row_mask:0xf bank_mask:0xf
    v_max_f32_dpp v145, v145, v145 row_mirror row_mask:0xf bank_mask:0xf
    v_max_f32_dpp v146, v146, v146 row_mirror row_mask:0xf bank_mask:0xf
    v_max_f32_dpp v147, v147, v147 row_mirror row_mask:0xf bank_mask:0xf
    v_mov_b32 v148, v144
    v_mov_b32 v149, v145
    v_mov_b32 v150, v146
    v_mov_b32 v151, v147
    s_nop 1
    v_permlane16_swap_b32 v144, v148
    v_permlane16_swap_b32 v145, v149
    v_permlane16_swap_b32 v146, v150
    v_permlane16_swap_b32 v147, v151
    v_max_f32 v144, v144, v148
    v_max_f32 v145, v145, v149
    v_max_f32 v146, v146, v150
    v_max_f32 v147, v147, v151
    s_nop 1
    v_mov_b32 v148, v144
    v_mov_b32 v149, v145
    v_mov_b32 v150, v146
    v_mov_b32 v151, v147
    s_nop 1
    v_permlane32_swap_b32 v144, v148
    v_permlane32_swap_b32 v145, v149
    v_permlane32_swap_b32 v146, v150
    v_permlane32_swap_b32 v147, v151
    v_max_f32 v144, v144, v148
    v_max_f32 v145, v145, v149
    v_max_f32 v146, v146, v150
    v_max_f32 v147, v147, v151
    s_nop 1
    s_mov_b32 s52, 0x3e0293ee
    v_mul_f32 v144, s52, v144
    v_mul_f32 v145, s52, v145
    v_mul_f32 v146, s52, v146
    v_mul_f32 v147, s52, v147
    v_fma_f32 v160, v160, s52, -v144
    v_fma_f32 v161, v161, s52, -v145
    v_fma_f32 v162, v162, s52, -v146
    v_fma_f32 v163, v163, s52, -v147
    v_exp_f32 v160, v160
    v_exp_f32 v161, v161
    v_exp_f32 v162, v162
    v_exp_f32 v163, v163
    s_nop 0
    v_mov_b32 v152, v160
    v_mov_b32 v153, v161
    v_mov_b32 v154, v162
    v_mov_b32 v155, v163
    s_nop 1
    v_add_f32_dpp v152, v152, v152 quad_perm:[1,0,3,2] row_mask:0xf bank_mask:0xf
    v_add_f32_dpp v153, v153, v153 quad_perm:[1,0,3,2] row_mask:0xf bank_mask:0xf
    v_add_f32_dpp v154, v154, v154 quad_perm:[1,0,3,2] row_mask:0xf bank_mask:0xf
    v_add_f32_dpp v155, v155, v155 quad_perm:[1,0,3,2] row_mask:0xf bank_mask:0xf
    v_add_f32_dpp v152, v152, v152 quad_perm:[2,3,0,1] row_mask:0xf bank_mask:0xf
    v_add_f32_dpp v153, v153, v153 quad_perm:[2,3,0,1] row_mask:0xf bank_mask:0xf
    v_add_f32_dpp v154, v154, v154 quad_perm:[2,3,0,1] row_mask:0xf bank_mask:0xf
    v_add_f32_dpp v155, v155, v155 quad_perm:[2,3,0,1] row_mask:0xf bank_mask:0xf
    v_add_f32_dpp v152, v152, v152 row_half_mirror row_mask:0xf bank_mask:0xf
    v_add_f32_dpp v153, v153, v153 row_half_mirror row_mask:0xf bank_mask:0xf
    v_add_f32_dpp v154, v154, v154 row_half_mirror row_mask:0xf bank_mask:0xf
    v_add_f32_dpp v155, v155, v155 row_half_mirror row_mask:0xf bank_mask:0xf
    v_add_f32_dpp v152, v152, v152 row_mirror row_mask:0xf bank_mask:0xf
    v_add_f32_dpp v153, v153, v153 row_mirror row_mask:0xf bank_mask:0xf
    v_add_f32_dpp v154, v154, v154 row_mirror row_mask:0xf bank_mask:0xf
    v_add_f32_dpp v155, v155, v155 row_mirror row_mask:0xf bank_mask:0xf
    v_mov_b32 v148, v152
    v_mov_b32 v149, v153
    v_mov_b32 v150, v154
    v_mov_b32 v151, v155
    s_nop 1
    v_permlane16_swap_b32 v152, v148
    v_permlane16_swap_b32 v153, v149
    v_permlane16_swap_b32 v154, v150
    v_permlane16_swap_b32 v155, v151
    v_add_f32 v152, v152, v148
    v_add_f32 v153, v153, v149
    v_add_f32 v154, v154, v150
    v_add_f32 v155, v155, v151
    s_nop 1
    v_mov_b32 v148, v152
    v_mov_b32 v149, v153
    v_mov_b32 v150, v154
    v_mov_b32 v151, v155
    s_nop 1
    v_permlane32_swap_b32 v152, v148
    v_permlane32_swap_b32 v153, v149
    v_permlane32_swap_b32 v154, v150
    v_permlane32_swap_b32 v155, v151
    v_add_f32 v152, v152, v148
    v_add_f32 v153, v153, v149
    v_add_f32 v154, v154, v150
    v_add_f32 v155, v155, v151
    s_nop 1
    s_waitcnt vmcnt(19)
    v_lshlrev_b32 v196, 16, v80
    v_and_b32 v197, 0xffff0000, v80
    v_lshlrev_b32 v198, 16, v81
    v_and_b32 v199, 0xffff0000, v81
    v_lshlrev_b32 v200, 16, v82
    v_and_b32 v201, 0xffff0000, v82
    v_lshlrev_b32 v202, 16, v83
    v_and_b32 v203, 0xffff0000, v83
    v_mul_f32_dpp v164, v160, v196 row_newbcast:0 row_mask:0xf bank_mask:0xf
    v_mul_f32_dpp v165, v160, v197 row_newbcast:0 row_mask:0xf bank_mask:0xf
    v_mul_f32_dpp v166, v160, v198 row_newbcast:0 row_mask:0xf bank_mask:0xf
    v_mul_f32_dpp v167, v160, v199 row_newbcast:0 row_mask:0xf bank_mask:0xf
    v_mul_f32_dpp v168, v160, v200 row_newbcast:0 row_mask:0xf bank_mask:0xf
    v_mul_f32_dpp v169, v160, v201 row_newbcast:0 row_mask:0xf bank_mask:0xf
    v_mul_f32_dpp v170, v160, v202 row_newbcast:0 row_mask:0xf bank_mask:0xf
    v_mul_f32_dpp v171, v160, v203 row_newbcast:0 row_mask:0xf bank_mask:0xf
    v_mul_f32_dpp v172, v161, v196 row_newbcast:0 row_mask:0xf bank_mask:0xf
    v_mul_f32_dpp v173, v161, v197 row_newbcast:0 row_mask:0xf bank_mask:0xf
    v_mul_f32_dpp v174, v161, v198 row_newbcast:0 row_mask:0xf bank_mask:0xf
    v_mul_f32_dpp v175, v161, v199 row_newbcast:0 row_mask:0xf bank_mask:0xf
    v_mul_f32_dpp v176, v161, v200 row_newbcast:0 row_mask:0xf bank_mask:0xf
    v_mul_f32_dpp v177, v161, v201 row_newbcast:0 row_mask:0xf bank_mask:0xf
    v_mul_f32_dpp v178, v161, v202 row_newbcast:0 row_mask:0xf bank_mask:0xf
    v_mul_f32_dpp v179, v161, v203 row_newbcast:0 row_mask:0xf bank_mask:0xf
    v_mul_f32_dpp v180, v162, v196 row_newbcast:0 row_mask:0xf bank_mask:0xf
    v_mul_f32_dpp v181, v162, v197 row_newbcast:0 row_mask:0xf bank_mask:0xf
    v_mul_f32_dpp v182, v162, v198 row_newbcast:0 row_mask:0xf bank_mask:0xf
    v_mul_f32_dpp v183, v162, v199 row_newbcast:0 row_mask:0xf bank_mask:0xf
    v_mul_f32_dpp v184, v162, v200 row_newbcast:0 row_mask:0xf bank_mask:0xf
    v_mul_f32_dpp v185, v162, v201 row_newbcast:0 row_mask:0xf bank_mask:0xf
    v_mul_f32_dpp v186, v162, v202 row_newbcast:0 row_mask:0xf bank_mask:0xf
    v_mul_f32_dpp v187, v162, v203 row_newbcast:0 row_mask:0xf bank_mask:0xf
    v_mul_f32_dpp v188, v163, v196 row_newbcast:0 row_mask:0xf bank_mask:0xf
    v_mul_f32_dpp v189, v163, v197 row_newbcast:0 row_mask:0xf bank_mask:0xf
    v_mul_f32_dpp v190, v163, v198 row_newbcast:0 row_mask:0xf bank_mask:0xf
    v_mul_f32_dpp v191, v163, v199 row_newbcast:0 row_mask:0xf bank_mask:0xf
    v_mul_f32_dpp v192, v163, v200 row_newbcast:0 row_mask:0xf bank_mask:0xf
    v_mul_f32_dpp v193, v163, v201 row_newbcast:0 row_mask:0xf bank_mask:0xf
    v_mul_f32_dpp v194, v163, v202 row_newbcast:0 row_mask:0xf bank_mask:0xf
    v_mul_f32_dpp v195, v163, v203 row_newbcast:0 row_mask:0xf bank_mask:0xf
    s_waitcnt vmcnt(18)
    v_lshlrev_b32 v196, 16, v84
    v_and_b32 v197, 0xffff0000, v84
    v_lshlrev_b32 v198, 16, v85
    v_and_b32 v199, 0xffff0000, v85
    v_lshlrev_b32 v200, 16, v86
    v_and_b32 v201, 0xffff0000, v86
    v_lshlrev_b32 v202, 16, v87
    v_and_b32 v203, 0xffff0000, v87
    v_fmac_f32_dpp v164, v160, v196 row_newbcast:1 row_mask:0xf bank_mask:0xf
    v_fmac_f32_dpp v165, v160, v197 row_newbcast:1 row_mask:0xf bank_mask:0xf
    v_fmac_f32_dpp v166, v160, v198 row_newbcast:1 row_mask:0xf bank_mask:0xf
    v_fmac_f32_dpp v167, v160, v199 row_newbcast:1 row_mask:0xf bank_mask:0xf
    v_fmac_f32_dpp v168, v160, v200 row_newbcast:1 row_mask:0xf bank_mask:0xf
    v_fmac_f32_dpp v169, v160, v201 row_newbcast:1 row_mask:0xf bank_mask:0xf
    v_fmac_f32_dpp v170, v160, v202 row_newbcast:1 row_mask:0xf bank_mask:0xf
    v_fmac_f32_dpp v171, v160, v203 row_newbcast:1 row_mask:0xf bank_mask:0xf
    v_fmac_f32_dpp v172, v161, v196 row_newbcast:1 row_mask:0xf bank_mask:0xf
    v_fmac_f32_dpp v173, v161, v197 row_newbcast:1 row_mask:0xf bank_mask:0xf
    v_fmac_f32_dpp v174, v161, v198 row_newbcast:1 row_mask:0xf bank_mask:0xf
    v_fmac_f32_dpp v175, v161, v199 row_newbcast:1 row_mask:0xf bank_mask:0xf
    v_fmac_f32_dpp v176, v161, v200 row_newbcast:1 row_mask:0xf bank_mask:0xf
    v_fmac_f32_dpp v177, v161, v201 row_newbcast:1 row_mask:0xf bank_mask:0xf
    v_fmac_f32_dpp v178, v161, v202 row_newbcast:1 row_mask:0xf bank_mask:0xf
    v_fmac_f32_dpp v179, v161, v203 row_newbcast:1 row_mask:0xf bank_mask:0xf
    v_fmac_f32_dpp v180, v162, v196 row_newbcast:1 row_mask:0xf bank_mask:0xf
    v_fmac_f32_dpp v181, v162, v197 row_newbcast:1 row_mask:0xf bank_mask:0xf
    v_fmac_f32_dpp v182, v162, v198 row_newbcast:1 row_mask:0xf bank_mask:0xf
    v_fmac_f32_dpp v183, v162, v199 row_newbcast:1 row_mask:0xf bank_mask:0xf
    v_fmac_f32_dpp v184, v162, v200 row_newbcast:1 row_mask:0xf bank_mask:0xf
    v_fmac_f32_dpp v185, v162, v201 row_newbcast:1 row_mask:0xf bank_mask:0xf
    v_fmac_f32_dpp v186, v162, v202 row_newbcast:1 row_mask:0xf bank_mask:0xf
    v_fmac_f32_dpp v187, v162, v203 row_newbcast:1 row_mask:0xf bank_mask:0xf
    v_fmac_f32_dpp v188, v163, v196 row_newbcast:1 row_mask:0xf bank_mask:0xf
    v_fmac_f32_dpp v189, v163, v197 row_newbcast:1 row_mask:0xf bank_mask:0xf
    v_fmac_f32_dpp v190, v163, v198 row_newbcast:1 row_mask:0xf bank_mask:0xf
    v_fmac_f32_dpp v191, v163, v199 row_newbcast:1 row_mask:0xf bank_mask:0xf
    v_fmac_f32_dpp v192, v163, v200 row_newbcast:1 row_mask:0xf bank_mask:0xf
    v_fmac_f32_dpp v193, v163, v201 row_newbcast:1 row_mask:0xf bank_mask:0xf
    v_fmac_f32_dpp v194, v163, v202 row_newbcast:1 row_mask:0xf bank_mask:0xf
    v_fmac_f32_dpp v195, v163, v203 row_newbcast:1 row_mask:0xf bank_mask:0xf
    s_waitcnt vmcnt(17)
    v_lshlrev_b32 v196, 16, v88
    v_and_b32 v197, 0xffff0000, v88
    v_lshlrev_b32 v198, 16, v89
    v_and_b32 v199, 0xffff0000, v89
    v_lshlrev_b32 v200, 16, v90
    v_and_b32 v201, 0xffff0000, v90
    v_lshlrev_b32 v202, 16, v91
    v_and_b32 v203, 0xffff0000, v91
    v_fmac_f32_dpp v164, v160, v196 row_newbcast:2 row_mask:0xf bank_mask:0xf
    v_fmac_f32_dpp v165, v160, v197 row_newbcast:2 row_mask:0xf bank_mask:0xf
    v_fmac_f32_dpp v166, v160, v198 row_newbcast:2 row_mask:0xf bank_mask:0xf
    v_fmac_f32_dpp v167, v160, v199 row_newbcast:2 row_mask:0xf bank_mask:0xf
    v_fmac_f32_dpp v168, v160, v200 row_newbcast:2 row_mask:0xf bank_mask:0xf
    v_fmac_f32_dpp v169, v160, v201 row_newbcast:2 row_mask:0xf bank_mask:0xf
    v_fmac_f32_dpp v170, v160, v202 row_newbcast:2 row_mask:0xf bank_mask:0xf
    v_fmac_f32_dpp v171, v160, v203 row_newbcast:2 row_mask:0xf bank_mask:0xf
    v_fmac_f32_dpp v172, v161, v196 row_newbcast:2 row_mask:0xf bank_mask:0xf
    v_fmac_f32_dpp v173, v161, v197 row_newbcast:2 row_mask:0xf bank_mask:0xf
    v_fmac_f32_dpp v174, v161, v198 row_newbcast:2 row_mask:0xf bank_mask:0xf
    v_fmac_f32_dpp v175, v161, v199 row_newbcast:2 row_mask:0xf bank_mask:0xf
    v_fmac_f32_dpp v176, v161, v200 row_newbcast:2 row_mask:0xf bank_mask:0xf
    v_fmac_f32_dpp v177, v161, v201 row_newbcast:2 row_mask:0xf bank_mask:0xf
    v_fmac_f32_dpp v178, v161, v202 row_newbcast:2 row_mask:0xf bank_mask:0xf
    v_fmac_f32_dpp v179, v161, v203 row_newbcast:2 row_mask:0xf bank_mask:0xf
    v_fmac_f32_dpp v180, v162, v196 row_newbcast:2 row_mask:0xf bank_mask:0xf
    v_fmac_f32_dpp v181, v162, v197 row_newbcast:2 row_mask:0xf bank_mask:0xf
    v_fmac_f32_dpp v182, v162, v198 row_newbcast:2 row_mask:0xf bank_mask:0xf
    v_fmac_f32_dpp v183, v162, v199 row_newbcast:2 row_mask:0xf bank_mask:0xf
    v_fmac_f32_dpp v184, v162, v200 row_newbcast:2 row_mask:0xf bank_mask:0xf
    v_fmac_f32_dpp v185, v162, v201 row_newbcast:2 row_mask:0xf bank_mask:0xf
    v_fmac_f32_dpp v186, v162, v202 row_newbcast:2 row_mask:0xf bank_mask:0xf
    v_fmac_f32_dpp v187, v162, v203 row_newbcast:2 row_mask:0xf bank_mask:0xf
    v_fmac_f32_dpp v188, v163, v196 row_newbcast:2 row_mask:0xf bank_mask:0xf
    v_fmac_f32_dpp v189, v163, v197 row_newbcast:2 row_mask:0xf bank_mask:0xf
    v_fmac_f32_dpp v190, v163, v198 row_newbcast:2 row_mask:0xf bank_mask:0xf
    v_fmac_f32_dpp v191, v163, v199 row_newbcast:2 row_mask:0xf bank_mask:0xf
    v_fmac_f32_dpp v192, v163, v200 row_newbcast:2 row_mask:0xf bank_mask:0xf
    v_fmac_f32_dpp v193, v163, v201 row_newbcast:2 row_mask:0xf bank_mask:0xf
    v_fmac_f32_dpp v194, v163, v202 row_newbcast:2 row_mask:0xf bank_mask:0xf
    v_fmac_f32_dpp v195, v163, v203 row_newbcast:2 row_mask:0xf bank_mask:0xf
    s_waitcnt vmcnt(16)
    v_lshlrev_b32 v196, 16, v92
    v_and_b32 v197, 0xffff0000, v92
    v_lshlrev_b32 v198, 16, v93
    v_and_b32 v199, 0xffff0000, v93
    v_lshlrev_b32 v200, 16, v94
    v_and_b32 v201, 0xffff0000, v94
    v_lshlrev_b32 v202, 16, v95
    v_and_b32 v203, 0xffff0000, v95
    v_fmac_f32_dpp v164, v160, v196 row_newbcast:3 row_mask:0xf bank_mask:0xf
    v_fmac_f32_dpp v165, v160, v197 row_newbcast:3 row_mask:0xf bank_mask:0xf
    v_fmac_f32_dpp v166, v160, v198 row_newbcast:3 row_mask:0xf bank_mask:0xf
    v_fmac_f32_dpp v167, v160, v199 row_newbcast:3 row_mask:0xf bank_mask:0xf
    v_fmac_f32_dpp v168, v160, v200 row_newbcast:3 row_mask:0xf bank_mask:0xf
    v_fmac_f32_dpp v169, v160, v201 row_newbcast:3 row_mask:0xf bank_mask:0xf
    v_fmac_f32_dpp v170, v160, v202 row_newbcast:3 row_mask:0xf bank_mask:0xf
    v_fmac_f32_dpp v171, v160, v203 row_newbcast:3 row_mask:0xf bank_mask:0xf
    v_fmac_f32_dpp v172, v161, v196 row_newbcast:3 row_mask:0xf bank_mask:0xf
    v_fmac_f32_dpp v173, v161, v197 row_newbcast:3 row_mask:0xf bank_mask:0xf
    v_fmac_f32_dpp v174, v161, v198 row_newbcast:3 row_mask:0xf bank_mask:0xf
    v_fmac_f32_dpp v175, v161, v199 row_newbcast:3 row_mask:0xf bank_mask:0xf
    v_fmac_f32_dpp v176, v161, v200 row_newbcast:3 row_mask:0xf bank_mask:0xf
    v_fmac_f32_dpp v177, v161, v201 row_newbcast:3 row_mask:0xf bank_mask:0xf
    v_fmac_f32_dpp v178, v161, v202 row_newbcast:3 row_mask:0xf bank_mask:0xf
    v_fmac_f32_dpp v179, v161, v203 row_newbcast:3 row_mask:0xf bank_mask:0xf
    v_fmac_f32_dpp v180, v162, v196 row_newbcast:3 row_mask:0xf bank_mask:0xf
    v_fmac_f32_dpp v181, v162, v197 row_newbcast:3 row_mask:0xf bank_mask:0xf
    v_fmac_f32_dpp v182, v162, v198 row_newbcast:3 row_mask:0xf bank_mask:0xf
    v_fmac_f32_dpp v183, v162, v199 row_newbcast:3 row_mask:0xf bank_mask:0xf
    v_fmac_f32_dpp v184, v162, v200 row_newbcast:3 row_mask:0xf bank_mask:0xf
    v_fmac_f32_dpp v185, v162, v201 row_newbcast:3 row_mask:0xf bank_mask:0xf
    v_fmac_f32_dpp v186, v162, v202 row_newbcast:3 row_mask:0xf bank_mask:0xf
    v_fmac_f32_dpp v187, v162, v203 row_newbcast:3 row_mask:0xf bank_mask:0xf
    v_fmac_f32_dpp v188, v163, v196 row_newbcast:3 row_mask:0xf bank_mask:0xf
    v_fmac_f32_dpp v189, v163, v197 row_newbcast:3 row_mask:0xf bank_mask:0xf
    v_fmac_f32_dpp v190, v163, v198 row_newbcast:3 row_mask:0xf bank_mask:0xf
    v_fmac_f32_dpp v191, v163, v199 row_newbcast:3 row_mask:0xf bank_mask:0xf
    v_fmac_f32_dpp v192, v163, v200 row_newbcast:3 row_mask:0xf bank_mask:0xf
    v_fmac_f32_dpp v193, v163, v201 row_newbcast:3 row_mask:0xf bank_mask:0xf
    v_fmac_f32_dpp v194, v163, v202 row_newbcast:3 row_mask:0xf bank_mask:0xf
    v_fmac_f32_dpp v195, v163, v203 row_newbcast:3 row_mask:0xf bank_mask:0xf
    s_waitcnt vmcnt(15)
    v_lshlrev_b32 v196, 16, v96
    v_and_b32 v197, 0xffff0000, v96
    v_lshlrev_b32 v198, 16, v97
    v_and_b32 v199, 0xffff0000, v97
    v_lshlrev_b32 v200, 16, v98
    v_and_b32 v201, 0xffff0000, v98
    v_lshlrev_b32 v202, 16, v99
    v_and_b32 v203, 0xffff0000, v99
    v_fmac_f32_dpp v164, v160, v196 row_newbcast:4 row_mask:0xf bank_mask:0xf
    v_fmac_f32_dpp v165, v160, v197 row_newbcast:4 row_mask:0xf bank_mask:0xf
    v_fmac_f32_dpp v166, v160, v198 row_newbcast:4 row_mask:0xf bank_mask:0xf
    v_fmac_f32_dpp v167, v160, v199 row_newbcast:4 row_mask:0xf bank_mask:0xf
    v_fmac_f32_dpp v168, v160, v200 row_newbcast:4 row_mask:0xf bank_mask:0xf
    v_fmac_f32_dpp v169, v160, v201 row_newbcast:4 row_mask:0xf bank_mask:0xf
    v_fmac_f32_dpp v170, v160, v202 row_newbcast:4 row_mask:0xf bank_mask:0xf
    v_fmac_f32_dpp v171, v160, v203 row_newbcast:4 row_mask:0xf bank_mask:0xf
    v_fmac_f32_dpp v172, v161, v196 row_newbcast:4 row_mask:0xf bank_mask:0xf
    v_fmac_f32_dpp v173, v161, v197 row_newbcast:4 row_mask:0xf bank_mask:0xf
    v_fmac_f32_dpp v174, v161, v198 row_newbcast:4 row_mask:0xf bank_mask:0xf
    v_fmac_f32_dpp v175, v161, v199 row_newbcast:4 row_mask:0xf bank_mask:0xf
    v_fmac_f32_dpp v176, v161, v200 row_newbcast:4 row_mask:0xf bank_mask:0xf
    v_fmac_f32_dpp v177, v161, v201 row_newbcast:4 row_mask:0xf bank_mask:0xf
    v_fmac_f32_dpp v178, v161, v202 row_newbcast:4 row_mask:0xf bank_mask:0xf
    v_fmac_f32_dpp v179, v161, v203 row_newbcast:4 row_mask:0xf bank_mask:0xf
    v_fmac_f32_dpp v180, v162, v196 row_newbcast:4 row_mask:0xf bank_mask:0xf
    v_fmac_f32_dpp v181, v162, v197 row_newbcast:4 row_mask:0xf bank_mask:0xf
    v_fmac_f32_dpp v182, v162, v198 row_newbcast:4 row_mask:0xf bank_mask:0xf
    v_fmac_f32_dpp v183, v162, v199 row_newbcast:4 row_mask:0xf bank_mask:0xf
    v_fmac_f32_dpp v184, v162, v200 row_newbcast:4 row_mask:0xf bank_mask:0xf
    v_fmac_f32_dpp v185, v162, v201 row_newbcast:4 row_mask:0xf bank_mask:0xf
    v_fmac_f32_dpp v186, v162, v202 row_newbcast:4 row_mask:0xf bank_mask:0xf
    v_fmac_f32_dpp v187, v162, v203 row_newbcast:4 row_mask:0xf bank_mask:0xf
    v_fmac_f32_dpp v188, v163, v196 row_newbcast:4 row_mask:0xf bank_mask:0xf
    v_fmac_f32_dpp v189, v163, v197 row_newbcast:4 row_mask:0xf bank_mask:0xf
    v_fmac_f32_dpp v190, v163, v198 row_newbcast:4 row_mask:0xf bank_mask:0xf
    v_fmac_f32_dpp v191, v163, v199 row_newbcast:4 row_mask:0xf bank_mask:0xf
    v_fmac_f32_dpp v192, v163, v200 row_newbcast:4 row_mask:0xf bank_mask:0xf
    v_fmac_f32_dpp v193, v163, v201 row_newbcast:4 row_mask:0xf bank_mask:0xf
    v_fmac_f32_dpp v194, v163, v202 row_newbcast:4 row_mask:0xf bank_mask:0xf
    v_fmac_f32_dpp v195, v163, v203 row_newbcast:4 row_mask:0xf bank_mask:0xf
    s_waitcnt vmcnt(14)
    v_lshlrev_b32 v196, 16, v100
    v_and_b32 v197, 0xffff0000, v100
    v_lshlrev_b32 v198, 16, v101
    v_and_b32 v199, 0xffff0000, v101
    v_lshlrev_b32 v200, 16, v102
    v_and_b32 v201, 0xffff0000, v102
    v_lshlrev_b32 v202, 16, v103
    v_and_b32 v203, 0xffff0000, v103
    v_fmac_f32_dpp v164, v160, v196 row_newbcast:5 row_mask:0xf bank_mask:0xf
    v_fmac_f32_dpp v165, v160, v197 row_newbcast:5 row_mask:0xf bank_mask:0xf
    v_fmac_f32_dpp v166, v160, v198 row_newbcast:5 row_mask:0xf bank_mask:0xf
    v_fmac_f32_dpp v167, v160, v199 row_newbcast:5 row_mask:0xf bank_mask:0xf
    v_fmac_f32_dpp v168, v160, v200 row_newbcast:5 row_mask:0xf bank_mask:0xf
    v_fmac_f32_dpp v169, v160, v201 row_newbcast:5 row_mask:0xf bank_mask:0xf
    v_fmac_f32_dpp v170, v160, v202 row_newbcast:5 row_mask:0xf bank_mask:0xf
    v_fmac_f32_dpp v171, v160, v203 row_newbcast:5 row_mask:0xf bank_mask:0xf
    v_fmac_f32_dpp v172, v161, v196 row_newbcast:5 row_mask:0xf bank_mask:0xf
    v_fmac_f32_dpp v173, v161, v197 row_newbcast:5 row_mask:0xf bank_mask:0xf
    v_fmac_f32_dpp v174, v161, v198 row_newbcast:5 row_mask:0xf bank_mask:0xf
    v_fmac_f32_dpp v175, v161, v199 row_newbcast:5 row_mask:0xf bank_mask:0xf
    v_fmac_f32_dpp v176, v161, v200 row_newbcast:5 row_mask:0xf bank_mask:0xf
    v_fmac_f32_dpp v177, v161, v201 row_newbcast:5 row_mask:0xf bank_mask:0xf
    v_fmac_f32_dpp v178, v161, v202 row_newbcast:5 row_mask:0xf bank_mask:0xf
    v_fmac_f32_dpp v179, v161, v203 row_newbcast:5 row_mask:0xf bank_mask:0xf
    v_fmac_f32_dpp v180, v162, v196 row_newbcast:5 row_mask:0xf bank_mask:0xf
    v_fmac_f32_dpp v181, v162, v197 row_newbcast:5 row_mask:0xf bank_mask:0xf
    v_fmac_f32_dpp v182, v162, v198 row_newbcast:5 row_mask:0xf bank_mask:0xf
    v_fmac_f32_dpp v183, v162, v199 row_newbcast:5 row_mask:0xf bank_mask:0xf
    v_fmac_f32_dpp v184, v162, v200 row_newbcast:5 row_mask:0xf bank_mask:0xf
    v_fmac_f32_dpp v185, v162, v201 row_newbcast:5 row_mask:0xf bank_mask:0xf
    v_fmac_f32_dpp v186, v162, v202 row_newbcast:5 row_mask:0xf bank_mask:0xf
    v_fmac_f32_dpp v187, v162, v203 row_newbcast:5 row_mask:0xf bank_mask:0xf
    v_fmac_f32_dpp v188, v163, v196 row_newbcast:5 row_mask:0xf bank_mask:0xf
    v_fmac_f32_dpp v189, v163, v197 row_newbcast:5 row_mask:0xf bank_mask:0xf
    v_fmac_f32_dpp v190, v163, v198 row_newbcast:5 row_mask:0xf bank_mask:0xf
    v_fmac_f32_dpp v191, v163, v199 row_newbcast:5 row_mask:0xf bank_mask:0xf
    v_fmac_f32_dpp v192, v163, v200 row_newbcast:5 row_mask:0xf bank_mask:0xf
    v_fmac_f32_dpp v193, v163, v201 row_newbcast:5 row_mask:0xf bank_mask:0xf
    v_fmac_f32_dpp v194, v163, v202 row_newbcast:5 row_mask:0xf bank_mask:0xf
    v_fmac_f32_dpp v195, v163, v203 row_newbcast:5 row_mask:0xf bank_mask:0xf
    s_waitcnt vmcnt(13)
    v_lshlrev_b32 v196, 16, v104
    v_and_b32 v197, 0xffff0000, v104
    v_lshlrev_b32 v198, 16, v105
    v_and_b32 v199, 0xffff0000, v105
    v_lshlrev_b32 v200, 16, v106
    v_and_b32 v201, 0xffff0000, v106
    v_lshlrev_b32 v202, 16, v107
    v_and_b32 v203, 0xffff0000, v107
    v_fmac_f32_dpp v164, v160, v196 row_newbcast:6 row_mask:0xf bank_mask:0xf
    v_fmac_f32_dpp v165, v160, v197 row_newbcast:6 row_mask:0xf bank_mask:0xf
    v_fmac_f32_dpp v166, v160, v198 row_newbcast:6 row_mask:0xf bank_mask:0xf
    v_fmac_f32_dpp v167, v160, v199 row_newbcast:6 row_mask:0xf bank_mask:0xf
    v_fmac_f32_dpp v168, v160, v200 row_newbcast:6 row_mask:0xf bank_mask:0xf
    v_fmac_f32_dpp v169, v160, v201 row_newbcast:6 row_mask:0xf bank_mask:0xf
    v_fmac_f32_dpp v170, v160, v202 row_newbcast:6 row_mask:0xf bank_mask:0xf
    v_fmac_f32_dpp v171, v160, v203 row_newbcast:6 row_mask:0xf bank_mask:0xf
    v_fmac_f32_dpp v172, v161, v196 row_newbcast:6 row_mask:0xf bank_mask:0xf
    v_fmac_f32_dpp v173, v161, v197 row_newbcast:6 row_mask:0xf bank_mask:0xf
    v_fmac_f32_dpp v174, v161, v198 row_newbcast:6 row_mask:0xf bank_mask:0xf
    v_fmac_f32_dpp v175, v161, v199 row_newbcast:6 row_mask:0xf bank_mask:0xf
    v_fmac_f32_dpp v176, v161, v200 row_newbcast:6 row_mask:0xf bank_mask:0xf
    v_fmac_f32_dpp v177, v161, v201 row_newbcast:6 row_mask:0xf bank_mask:0xf
    v_fmac_f32_dpp v178, v161, v202 row_newbcast:6 row_mask:0xf bank_mask:0xf
    v_fmac_f32_dpp v179, v161, v203 row_newbcast:6 row_mask:0xf bank_mask:0xf
    v_fmac_f32_dpp v180, v162, v196 row_newbcast:6 row_mask:0xf bank_mask:0xf
    v_fmac_f32_dpp v181, v162, v197 row_newbcast:6 row_mask:0xf bank_mask:0xf
    v_fmac_f32_dpp v182, v162, v198 row_newbcast:6 row_mask:0xf bank_mask:0xf
    v_fmac_f32_dpp v183, v162, v199 row_newbcast:6 row_mask:0xf bank_mask:0xf
    v_fmac_f32_dpp v184, v162, v200 row_newbcast:6 row_mask:0xf bank_mask:0xf
    v_fmac_f32_dpp v185, v162, v201 row_newbcast:6 row_mask:0xf bank_mask:0xf
    v_fmac_f32_dpp v186, v162, v202 row_newbcast:6 row_mask:0xf bank_mask:0xf
    v_fmac_f32_dpp v187, v162, v203 row_newbcast:6 row_mask:0xf bank_mask:0xf
    v_fmac_f32_dpp v188, v163, v196 row_newbcast:6 row_mask:0xf bank_mask:0xf
    v_fmac_f32_dpp v189, v163, v197 row_newbcast:6 row_mask:0xf bank_mask:0xf
    v_fmac_f32_dpp v190, v163, v198 row_newbcast:6 row_mask:0xf bank_mask:0xf
    v_fmac_f32_dpp v191, v163, v199 row_newbcast:6 row_mask:0xf bank_mask:0xf
    v_fmac_f32_dpp v192, v163, v200 row_newbcast:6 row_mask:0xf bank_mask:0xf
    v_fmac_f32_dpp v193, v163, v201 row_newbcast:6 row_mask:0xf bank_mask:0xf
    v_fmac_f32_dpp v194, v163, v202 row_newbcast:6 row_mask:0xf bank_mask:0xf
    v_fmac_f32_dpp v195, v163, v203 row_newbcast:6 row_mask:0xf bank_mask:0xf
    s_waitcnt vmcnt(12)
    v_lshlrev_b32 v196, 16, v108
    v_and_b32 v197, 0xffff0000, v108
    v_lshlrev_b32 v198, 16, v109
    v_and_b32 v199, 0xffff0000, v109
    v_lshlrev_b32 v200, 16, v110
    v_and_b32 v201, 0xffff0000, v110
    v_lshlrev_b32 v202, 16, v111
    v_and_b32 v203, 0xffff0000, v111
    v_fmac_f32_dpp v164, v160, v196 row_newbcast:7 row_mask:0xf bank_mask:0xf
    v_fmac_f32_dpp v165, v160, v197 row_newbcast:7 row_mask:0xf bank_mask:0xf
    v_fmac_f32_dpp v166, v160, v198 row_newbcast:7 row_mask:0xf bank_mask:0xf
    v_fmac_f32_dpp v167, v160, v199 row_newbcast:7 row_mask:0xf bank_mask:0xf
    v_fmac_f32_dpp v168, v160, v200 row_newbcast:7 row_mask:0xf bank_mask:0xf
    v_fmac_f32_dpp v169, v160, v201 row_newbcast:7 row_mask:0xf bank_mask:0xf
    v_fmac_f32_dpp v170, v160, v202 row_newbcast:7 row_mask:0xf bank_mask:0xf
    v_fmac_f32_dpp v171, v160, v203 row_newbcast:7 row_mask:0xf bank_mask:0xf
    v_fmac_f32_dpp v172, v161, v196 row_newbcast:7 row_mask:0xf bank_mask:0xf
    v_fmac_f32_dpp v173, v161, v197 row_newbcast:7 row_mask:0xf bank_mask:0xf
    v_fmac_f32_dpp v174, v161, v198 row_newbcast:7 row_mask:0xf bank_mask:0xf
    v_fmac_f32_dpp v175, v161, v199 row_newbcast:7 row_mask:0xf bank_mask:0xf
    v_fmac_f32_dpp v176, v161, v200 row_newbcast:7 row_mask:0xf bank_mask:0xf
    v_fmac_f32_dpp v177, v161, v201 row_newbcast:7 row_mask:0xf bank_mask:0xf
    v_fmac_f32_dpp v178, v161, v202 row_newbcast:7 row_mask:0xf bank_mask:0xf
    v_fmac_f32_dpp v179, v161, v203 row_newbcast:7 row_mask:0xf bank_mask:0xf
    v_fmac_f32_dpp v180, v162, v196 row_newbcast:7 row_mask:0xf bank_mask:0xf
    v_fmac_f32_dpp v181, v162, v197 row_newbcast:7 row_mask:0xf bank_mask:0xf
    v_fmac_f32_dpp v182, v162, v198 row_newbcast:7 row_mask:0xf bank_mask:0xf
    v_fmac_f32_dpp v183, v162, v199 row_newbcast:7 row_mask:0xf bank_mask:0xf
    v_fmac_f32_dpp v184, v162, v200 row_newbcast:7 row_mask:0xf bank_mask:0xf
    v_fmac_f32_dpp v185, v162, v201 row_newbcast:7 row_mask:0xf bank_mask:0xf
    v_fmac_f32_dpp v186, v162, v202 row_newbcast:7 row_mask:0xf bank_mask:0xf
    v_fmac_f32_dpp v187, v162, v203 row_newbcast:7 row_mask:0xf bank_mask:0xf
    v_fmac_f32_dpp v188, v163, v196 row_newbcast:7 row_mask:0xf bank_mask:0xf
    v_fmac_f32_dpp v189, v163, v197 row_newbcast:7 row_mask:0xf bank_mask:0xf
    v_fmac_f32_dpp v190, v163, v198 row_newbcast:7 row_mask:0xf bank_mask:0xf
    v_fmac_f32_dpp v191, v163, v199 row_newbcast:7 row_mask:0xf bank_mask:0xf
    v_fmac_f32_dpp v192, v163, v200 row_newbcast:7 row_mask:0xf bank_mask:0xf
    v_fmac_f32_dpp v193, v163, v201 row_newbcast:7 row_mask:0xf bank_mask:0xf
    v_fmac_f32_dpp v194, v163, v202 row_newbcast:7 row_mask:0xf bank_mask:0xf
    v_fmac_f32_dpp v195, v163, v203 row_newbcast:7 row_mask:0xf bank_mask:0xf
    s_waitcnt vmcnt(11)
    v_lshlrev_b32 v196, 16, v112
    v_and_b32 v197, 0xffff0000, v112
    v_lshlrev_b32 v198, 16, v113
    v_and_b32 v199, 0xffff0000, v113
    v_lshlrev_b32 v200, 16, v114
    v_and_b32 v201, 0xffff0000, v114
    v_lshlrev_b32 v202, 16, v115
    v_and_b32 v203, 0xffff0000, v115
    v_fmac_f32_dpp v164, v160, v196 row_newbcast:8 row_mask:0xf bank_mask:0xf
    v_fmac_f32_dpp v165, v160, v197 row_newbcast:8 row_mask:0xf bank_mask:0xf
    v_fmac_f32_dpp v166, v160, v198 row_newbcast:8 row_mask:0xf bank_mask:0xf
    v_fmac_f32_dpp v167, v160, v199 row_newbcast:8 row_mask:0xf bank_mask:0xf
    v_fmac_f32_dpp v168, v160, v200 row_newbcast:8 row_mask:0xf bank_mask:0xf
    v_fmac_f32_dpp v169, v160, v201 row_newbcast:8 row_mask:0xf bank_mask:0xf
    v_fmac_f32_dpp v170, v160, v202 row_newbcast:8 row_mask:0xf bank_mask:0xf
    v_fmac_f32_dpp v171, v160, v203 row_newbcast:8 row_mask:0xf bank_mask:0xf
    v_fmac_f32_dpp v172, v161, v196 row_newbcast:8 row_mask:0xf bank_mask:0xf
    v_fmac_f32_dpp v173, v161, v197 row_newbcast:8 row_mask:0xf bank_mask:0xf
    v_fmac_f32_dpp v174, v161, v198 row_newbcast:8 row_mask:0xf bank_mask:0xf
    v_fmac_f32_dpp v175, v161, v199 row_newbcast:8 row_mask:0xf bank_mask:0xf
    v_fmac_f32_dpp v176, v161, v200 row_newbcast:8 row_mask:0xf bank_mask:0xf
    v_fmac_f32_dpp v177, v161, v201 row_newbcast:8 row_mask:0xf bank_mask:0xf
    v_fmac_f32_dpp v178, v161, v202 row_newbcast:8 row_mask:0xf bank_mask:0xf
    v_fmac_f32_dpp v179, v161, v203 row_newbcast:8 row_mask:0xf bank_mask:0xf
    v_fmac_f32_dpp v180, v162, v196 row_newbcast:8 row_mask:0xf bank_mask:0xf
    v_fmac_f32_dpp v181, v162, v197 row_newbcast:8 row_mask:0xf bank_mask:0xf
    v_fmac_f32_dpp v182, v162, v198 row_newbcast:8 row_mask:0xf bank_mask:0xf
    v_fmac_f32_dpp v183, v162, v199 row_newbcast:8 row_mask:0xf bank_mask:0xf
    v_fmac_f32_dpp v184, v162, v200 row_newbcast:8 row_mask:0xf bank_mask:0xf
    v_fmac_f32_dpp v185, v162, v201 row_newbcast:8 row_mask:0xf bank_mask:0xf
    v_fmac_f32_dpp v186, v162, v202 row_newbcast:8 row_mask:0xf bank_mask:0xf
    v_fmac_f32_dpp v187, v162, v203 row_newbcast:8 row_mask:0xf bank_mask:0xf
    v_fmac_f32_dpp v188, v163, v196 row_newbcast:8 row_mask:0xf bank_mask:0xf
    v_fmac_f32_dpp v189, v163, v197 row_newbcast:8 row_mask:0xf bank_mask:0xf
    v_fmac_f32_dpp v190, v163, v198 row_newbcast:8 row_mask:0xf bank_mask:0xf
    v_fmac_f32_dpp v191, v163, v199 row_newbcast:8 row_mask:0xf bank_mask:0xf
    v_fmac_f32_dpp v192, v163, v200 row_newbcast:8 row_mask:0xf bank_mask:0xf
    v_fmac_f32_dpp v193, v163, v201 row_newbcast:8 row_mask:0xf bank_mask:0xf
    v_fmac_f32_dpp v194, v163, v202 row_newbcast:8 row_mask:0xf bank_mask:0xf
    v_fmac_f32_dpp v195, v163, v203 row_newbcast:8 row_mask:0xf bank_mask:0xf
    s_waitcnt vmcnt(10)
    v_lshlrev_b32 v196, 16, v116
    v_and_b32 v197, 0xffff0000, v116
    v_lshlrev_b32 v198, 16, v117
    v_and_b32 v199, 0xffff0000, v117
    v_lshlrev_b32 v200, 16, v118
    v_and_b32 v201, 0xffff0000, v118
    v_lshlrev_b32 v202, 16, v119
    v_and_b32 v203, 0xffff0000, v119
    v_fmac_f32_dpp v164, v160, v196 row_newbcast:9 row_mask:0xf bank_mask:0xf
    v_fmac_f32_dpp v165, v160, v197 row_newbcast:9 row_mask:0xf bank_mask:0xf
    v_fmac_f32_dpp v166, v160, v198 row_newbcast:9 row_mask:0xf bank_mask:0xf
    v_fmac_f32_dpp v167, v160, v199 row_newbcast:9 row_mask:0xf bank_mask:0xf
    v_fmac_f32_dpp v168, v160, v200 row_newbcast:9 row_mask:0xf bank_mask:0xf
    v_fmac_f32_dpp v169, v160, v201 row_newbcast:9 row_mask:0xf bank_mask:0xf
    v_fmac_f32_dpp v170, v160, v202 row_newbcast:9 row_mask:0xf bank_mask:0xf
    v_fmac_f32_dpp v171, v160, v203 row_newbcast:9 row_mask:0xf bank_mask:0xf
    v_fmac_f32_dpp v172, v161, v196 row_newbcast:9 row_mask:0xf bank_mask:0xf
    v_fmac_f32_dpp v173, v161, v197 row_newbcast:9 row_mask:0xf bank_mask:0xf
    v_fmac_f32_dpp v174, v161, v198 row_newbcast:9 row_mask:0xf bank_mask:0xf
    v_fmac_f32_dpp v175, v161, v199 row_newbcast:9 row_mask:0xf bank_mask:0xf
    v_fmac_f32_dpp v176, v161, v200 row_newbcast:9 row_mask:0xf bank_mask:0xf
    v_fmac_f32_dpp v177, v161, v201 row_newbcast:9 row_mask:0xf bank_mask:0xf
    v_fmac_f32_dpp v178, v161, v202 row_newbcast:9 row_mask:0xf bank_mask:0xf
    v_fmac_f32_dpp v179, v161, v203 row_newbcast:9 row_mask:0xf bank_mask:0xf
    v_fmac_f32_dpp v180, v162, v196 row_newbcast:9 row_mask:0xf bank_mask:0xf
    v_fmac_f32_dpp v181, v162, v197 row_newbcast:9 row_mask:0xf bank_mask:0xf
    v_fmac_f32_dpp v182, v162, v198 row_newbcast:9 row_mask:0xf bank_mask:0xf
    v_fmac_f32_dpp v183, v162, v199 row_newbcast:9 row_mask:0xf bank_mask:0xf
    v_fmac_f32_dpp v184, v162, v200 row_newbcast:9 row_mask:0xf bank_mask:0xf
    v_fmac_f32_dpp v185, v162, v201 row_newbcast:9 row_mask:0xf bank_mask:0xf
    v_fmac_f32_dpp v186, v162, v202 row_newbcast:9 row_mask:0xf bank_mask:0xf
    v_fmac_f32_dpp v187, v162, v203 row_newbcast:9 row_mask:0xf bank_mask:0xf
    v_fmac_f32_dpp v188, v163, v196 row_newbcast:9 row_mask:0xf bank_mask:0xf
    v_fmac_f32_dpp v189, v163, v197 row_newbcast:9 row_mask:0xf bank_mask:0xf
    v_fmac_f32_dpp v190, v163, v198 row_newbcast:9 row_mask:0xf bank_mask:0xf
    v_fmac_f32_dpp v191, v163, v199 row_newbcast:9 row_mask:0xf bank_mask:0xf
    v_fmac_f32_dpp v192, v163, v200 row_newbcast:9 row_mask:0xf bank_mask:0xf
    v_fmac_f32_dpp v193, v163, v201 row_newbcast:9 row_mask:0xf bank_mask:0xf
    v_fmac_f32_dpp v194, v163, v202 row_newbcast:9 row_mask:0xf bank_mask:0xf
    v_fmac_f32_dpp v195, v163, v203 row_newbcast:9 row_mask:0xf bank_mask:0xf
    s_waitcnt vmcnt(9)
    v_lshlrev_b32 v196, 16, v120
    v_and_b32 v197, 0xffff0000, v120
    v_lshlrev_b32 v198, 16, v121
    v_and_b32 v199, 0xffff0000, v121
    v_lshlrev_b32 v200, 16, v122
    v_and_b32 v201, 0xffff0000, v122
    v_lshlrev_b32 v202, 16, v123
    v_and_b32 v203, 0xffff0000, v123
    v_fmac_f32_dpp v164, v160, v196 row_newbcast:10 row_mask:0xf bank_mask:0xf
    v_fmac_f32_dpp v165, v160, v197 row_newbcast:10 row_mask:0xf bank_mask:0xf
    v_fmac_f32_dpp v166, v160, v198 row_newbcast:10 row_mask:0xf bank_mask:0xf
    v_fmac_f32_dpp v167, v160, v199 row_newbcast:10 row_mask:0xf bank_mask:0xf
    v_fmac_f32_dpp v168, v160, v200 row_newbcast:10 row_mask:0xf bank_mask:0xf
    v_fmac_f32_dpp v169, v160, v201 row_newbcast:10 row_mask:0xf bank_mask:0xf
    v_fmac_f32_dpp v170, v160, v202 row_newbcast:10 row_mask:0xf bank_mask:0xf
    v_fmac_f32_dpp v171, v160, v203 row_newbcast:10 row_mask:0xf bank_mask:0xf
    v_fmac_f32_dpp v172, v161, v196 row_newbcast:10 row_mask:0xf bank_mask:0xf
    v_fmac_f32_dpp v173, v161, v197 row_newbcast:10 row_mask:0xf bank_mask:0xf
    v_fmac_f32_dpp v174, v161, v198 row_newbcast:10 row_mask:0xf bank_mask:0xf
    v_fmac_f32_dpp v175, v161, v199 row_newbcast:10 row_mask:0xf bank_mask:0xf
    v_fmac_f32_dpp v176, v161, v200 row_newbcast:10 row_mask:0xf bank_mask:0xf
    v_fmac_f32_dpp v177, v161, v201 row_newbcast:10 row_mask:0xf bank_mask:0xf
    v_fmac_f32_dpp v178, v161, v202 row_newbcast:10 row_mask:0xf bank_mask:0xf
    v_fmac_f32_dpp v179, v161, v203 row_newbcast:10 row_mask:0xf bank_mask:0xf
    v_fmac_f32_dpp v180, v162, v196 row_newbcast:10 row_mask:0xf bank_mask:0xf
    v_fmac_f32_dpp v181, v162, v197 row_newbcast:10 row_mask:0xf bank_mask:0xf
    v_fmac_f32_dpp v182, v162, v198 row_newbcast:10 row_mask:0xf bank_mask:0xf
    v_fmac_f32_dpp v183, v162, v199 row_newbcast:10 row_mask:0xf bank_mask:0xf
    v_fmac_f32_dpp v184, v162, v200 row_newbcast:10 row_mask:0xf bank_mask:0xf
    v_fmac_f32_dpp v185, v162, v201 row_newbcast:10 row_mask:0xf bank_mask:0xf
    v_fmac_f32_dpp v186, v162, v202 row_newbcast:10 row_mask:0xf bank_mask:0xf
    v_fmac_f32_dpp v187, v162, v203 row_newbcast:10 row_mask:0xf bank_mask:0xf
    v_fmac_f32_dpp v188, v163, v196 row_newbcast:10 row_mask:0xf bank_mask:0xf
    v_fmac_f32_dpp v189, v163, v197 row_newbcast:10 row_mask:0xf bank_mask:0xf
    v_fmac_f32_dpp v190, v163, v198 row_newbcast:10 row_mask:0xf bank_mask:0xf
    v_fmac_f32_dpp v191, v163, v199 row_newbcast:10 row_mask:0xf bank_mask:0xf
    v_fmac_f32_dpp v192, v163, v200 row_newbcast:10 row_mask:0xf bank_mask:0xf
    v_fmac_f32_dpp v193, v163, v201 row_newbcast:10 row_mask:0xf bank_mask:0xf
    v_fmac_f32_dpp v194, v163, v202 row_newbcast:10 row_mask:0xf bank_mask:0xf
    v_fmac_f32_dpp v195, v163, v203 row_newbcast:10 row_mask:0xf bank_mask:0xf
    s_waitcnt vmcnt(8)
    v_lshlrev_b32 v196, 16, v124
    v_and_b32 v197, 0xffff0000, v124
    v_lshlrev_b32 v198, 16, v125
    v_and_b32 v199, 0xffff0000, v125
    v_lshlrev_b32 v200, 16, v126
    v_and_b32 v201, 0xffff0000, v126
    v_lshlrev_b32 v202, 16, v127
    v_and_b32 v203, 0xffff0000, v127
    v_fmac_f32_dpp v164, v160, v196 row_newbcast:11 row_mask:0xf bank_mask:0xf
    v_fmac_f32_dpp v165, v160, v197 row_newbcast:11 row_mask:0xf bank_mask:0xf
    v_fmac_f32_dpp v166, v160, v198 row_newbcast:11 row_mask:0xf bank_mask:0xf
    v_fmac_f32_dpp v167, v160, v199 row_newbcast:11 row_mask:0xf bank_mask:0xf
    v_fmac_f32_dpp v168, v160, v200 row_newbcast:11 row_mask:0xf bank_mask:0xf
    v_fmac_f32_dpp v169, v160, v201 row_newbcast:11 row_mask:0xf bank_mask:0xf
    v_fmac_f32_dpp v170, v160, v202 row_newbcast:11 row_mask:0xf bank_mask:0xf
    v_fmac_f32_dpp v171, v160, v203 row_newbcast:11 row_mask:0xf bank_mask:0xf
    v_fmac_f32_dpp v172, v161, v196 row_newbcast:11 row_mask:0xf bank_mask:0xf
    v_fmac_f32_dpp v173, v161, v197 row_newbcast:11 row_mask:0xf bank_mask:0xf
    v_fmac_f32_dpp v174, v161, v198 row_newbcast:11 row_mask:0xf bank_mask:0xf
    v_fmac_f32_dpp v175, v161, v199 row_newbcast:11 row_mask:0xf bank_mask:0xf
    v_fmac_f32_dpp v176, v161, v200 row_newbcast:11 row_mask:0xf bank_mask:0xf
    v_fmac_f32_dpp v177, v161, v201 row_newbcast:11 row_mask:0xf bank_mask:0xf
    v_fmac_f32_dpp v178, v161, v202 row_newbcast:11 row_mask:0xf bank_mask:0xf
    v_fmac_f32_dpp v179, v161, v203 row_newbcast:11 row_mask:0xf bank_mask:0xf
    v_fmac_f32_dpp v180, v162, v196 row_newbcast:11 row_mask:0xf bank_mask:0xf
    v_fmac_f32_dpp v181, v162, v197 row_newbcast:11 row_mask:0xf bank_mask:0xf
    v_fmac_f32_dpp v182, v162, v198 row_newbcast:11 row_mask:0xf bank_mask:0xf
    v_fmac_f32_dpp v183, v162, v199 row_newbcast:11 row_mask:0xf bank_mask:0xf
    v_fmac_f32_dpp v184, v162, v200 row_newbcast:11 row_mask:0xf bank_mask:0xf
    v_fmac_f32_dpp v185, v162, v201 row_newbcast:11 row_mask:0xf bank_mask:0xf
    v_fmac_f32_dpp v186, v162, v202 row_newbcast:11 row_mask:0xf bank_mask:0xf
    v_fmac_f32_dpp v187, v162, v203 row_newbcast:11 row_mask:0xf bank_mask:0xf
    v_fmac_f32_dpp v188, v163, v196 row_newbcast:11 row_mask:0xf bank_mask:0xf
    v_fmac_f32_dpp v189, v163, v197 row_newbcast:11 row_mask:0xf bank_mask:0xf
    v_fmac_f32_dpp v190, v163, v198 row_newbcast:11 row_mask:0xf bank_mask:0xf
    v_fmac_f32_dpp v191, v163, v199 row_newbcast:11 row_mask:0xf bank_mask:0xf
    v_fmac_f32_dpp v192, v163, v200 row_newbcast:11 row_mask:0xf bank_mask:0xf
    v_fmac_f32_dpp v193, v163, v201 row_newbcast:11 row_mask:0xf bank_mask:0xf
    v_fmac_f32_dpp v194, v163, v202 row_newbcast:11 row_mask:0xf bank_mask:0xf
    v_fmac_f32_dpp v195, v163, v203 row_newbcast:11 row_mask:0xf bank_mask:0xf
    s_waitcnt vmcnt(7)
    v_lshlrev_b32 v196, 16, v128
    v_and_b32 v197, 0xffff0000, v128
    v_lshlrev_b32 v198, 16, v129
    v_and_b32 v199, 0xffff0000, v129
    v_lshlrev_b32 v200, 16, v130
    v_and_b32 v201, 0xffff0000, v130
    v_lshlrev_b32 v202, 16, v131
    v_and_b32 v203, 0xffff0000, v131
    v_fmac_f32_dpp v164, v160, v196 row_newbcast:12 row_mask:0xf bank_mask:0xf
    v_fmac_f32_dpp v165, v160, v197 row_newbcast:12 row_mask:0xf bank_mask:0xf
    v_fmac_f32_dpp v166, v160, v198 row_newbcast:12 row_mask:0xf bank_mask:0xf
    v_fmac_f32_dpp v167, v160, v199 row_newbcast:12 row_mask:0xf bank_mask:0xf
    v_fmac_f32_dpp v168, v160, v200 row_newbcast:12 row_mask:0xf bank_mask:0xf
    v_fmac_f32_dpp v169, v160, v201 row_newbcast:12 row_mask:0xf bank_mask:0xf
    v_fmac_f32_dpp v170, v160, v202 row_newbcast:12 row_mask:0xf bank_mask:0xf
    v_fmac_f32_dpp v171, v160, v203 row_newbcast:12 row_mask:0xf bank_mask:0xf
    v_fmac_f32_dpp v172, v161, v196 row_newbcast:12 row_mask:0xf bank_mask:0xf
    v_fmac_f32_dpp v173, v161, v197 row_newbcast:12 row_mask:0xf bank_mask:0xf
    v_fmac_f32_dpp v174, v161, v198 row_newbcast:12 row_mask:0xf bank_mask:0xf
    v_fmac_f32_dpp v175, v161, v199 row_newbcast:12 row_mask:0xf bank_mask:0xf
    v_fmac_f32_dpp v176, v161, v200 row_newbcast:12 row_mask:0xf bank_mask:0xf
    v_fmac_f32_dpp v177, v161, v201 row_newbcast:12 row_mask:0xf bank_mask:0xf
    v_fmac_f32_dpp v178, v161, v202 row_newbcast:12 row_mask:0xf bank_mask:0xf
    v_fmac_f32_dpp v179, v161, v203 row_newbcast:12 row_mask:0xf bank_mask:0xf
    v_fmac_f32_dpp v180, v162, v196 row_newbcast:12 row_mask:0xf bank_mask:0xf
    v_fmac_f32_dpp v181, v162, v197 row_newbcast:12 row_mask:0xf bank_mask:0xf
    v_fmac_f32_dpp v182, v162, v198 row_newbcast:12 row_mask:0xf bank_mask:0xf
    v_fmac_f32_dpp v183, v162, v199 row_newbcast:12 row_mask:0xf bank_mask:0xf
    v_fmac_f32_dpp v184, v162, v200 row_newbcast:12 row_mask:0xf bank_mask:0xf
    v_fmac_f32_dpp v185, v162, v201 row_newbcast:12 row_mask:0xf bank_mask:0xf
    v_fmac_f32_dpp v186, v162, v202 row_newbcast:12 row_mask:0xf bank_mask:0xf
    v_fmac_f32_dpp v187, v162, v203 row_newbcast:12 row_mask:0xf bank_mask:0xf
    v_fmac_f32_dpp v188, v163, v196 row_newbcast:12 row_mask:0xf bank_mask:0xf
    v_fmac_f32_dpp v189, v163, v197 row_newbcast:12 row_mask:0xf bank_mask:0xf
    v_fmac_f32_dpp v190, v163, v198 row_newbcast:12 row_mask:0xf bank_mask:0xf
    v_fmac_f32_dpp v191, v163, v199 row_newbcast:12 row_mask:0xf bank_mask:0xf
    v_fmac_f32_dpp v192, v163, v200 row_newbcast:12 row_mask:0xf bank_mask:0xf
    v_fmac_f32_dpp v193, v163, v201 row_newbcast:12 row_mask:0xf bank_mask:0xf
    v_fmac_f32_dpp v194, v163, v202 row_newbcast:12 row_mask:0xf bank_mask:0xf
    v_fmac_f32_dpp v195, v163, v203 row_newbcast:12 row_mask:0xf bank_mask:0xf
    s_waitcnt vmcnt(6)
    v_lshlrev_b32 v196, 16, v132
    v_and_b32 v197, 0xffff0000, v132
    v_lshlrev_b32 v198, 16, v133
    v_and_b32 v199, 0xffff0000, v133
    v_lshlrev_b32 v200, 16, v134
    v_and_b32 v201, 0xffff0000, v134
    v_lshlrev_b32 v202, 16, v135
    v_and_b32 v203, 0xffff0000, v135
    v_fmac_f32_dpp v164, v160, v196 row_newbcast:13 row_mask:0xf bank_mask:0xf
    v_fmac_f32_dpp v165, v160, v197 row_newbcast:13 row_mask:0xf bank_mask:0xf
    v_fmac_f32_dpp v166, v160, v198 row_newbcast:13 row_mask:0xf bank_mask:0xf
    v_fmac_f32_dpp v167, v160, v199 row_newbcast:13 row_mask:0xf bank_mask:0xf
    v_fmac_f32_dpp v168, v160, v200 row_newbcast:13 row_mask:0xf bank_mask:0xf
    v_fmac_f32_dpp v169, v160, v201 row_newbcast:13 row_mask:0xf bank_mask:0xf
    v_fmac_f32_dpp v170, v160, v202 row_newbcast:13 row_mask:0xf bank_mask:0xf
    v_fmac_f32_dpp v171, v160, v203 row_newbcast:13 row_mask:0xf bank_mask:0xf
    v_fmac_f32_dpp v172, v161, v196 row_newbcast:13 row_mask:0xf bank_mask:0xf
    v_fmac_f32_dpp v173, v161, v197 row_newbcast:13 row_mask:0xf bank_mask:0xf
    v_fmac_f32_dpp v174, v161, v198 row_newbcast:13 row_mask:0xf bank_mask:0xf
    v_fmac_f32_dpp v175, v161, v199 row_newbcast:13 row_mask:0xf bank_mask:0xf
    v_fmac_f32_dpp v176, v161, v200 row_newbcast:13 row_mask:0xf bank_mask:0xf
    v_fmac_f32_dpp v177, v161, v201 row_newbcast:13 row_mask:0xf bank_mask:0xf
    v_fmac_f32_dpp v178, v161, v202 row_newbcast:13 row_mask:0xf bank_mask:0xf
    v_fmac_f32_dpp v179, v161, v203 row_newbcast:13 row_mask:0xf bank_mask:0xf
    v_fmac_f32_dpp v180, v162, v196 row_newbcast:13 row_mask:0xf bank_mask:0xf
    v_fmac_f32_dpp v181, v162, v197 row_newbcast:13 row_mask:0xf bank_mask:0xf
    v_fmac_f32_dpp v182, v162, v198 row_newbcast:13 row_mask:0xf bank_mask:0xf
    v_fmac_f32_dpp v183, v162, v199 row_newbcast:13 row_mask:0xf bank_mask:0xf
    v_fmac_f32_dpp v184, v162, v200 row_newbcast:13 row_mask:0xf bank_mask:0xf
    v_fmac_f32_dpp v185, v162, v201 row_newbcast:13 row_mask:0xf bank_mask:0xf
    v_fmac_f32_dpp v186, v162, v202 row_newbcast:13 row_mask:0xf bank_mask:0xf
    v_fmac_f32_dpp v187, v162, v203 row_newbcast:13 row_mask:0xf bank_mask:0xf
    v_fmac_f32_dpp v188, v163, v196 row_newbcast:13 row_mask:0xf bank_mask:0xf
    v_fmac_f32_dpp v189, v163, v197 row_newbcast:13 row_mask:0xf bank_mask:0xf
    v_fmac_f32_dpp v190, v163, v198 row_newbcast:13 row_mask:0xf bank_mask:0xf
    v_fmac_f32_dpp v191, v163, v199 row_newbcast:13 row_mask:0xf bank_mask:0xf
    v_fmac_f32_dpp v192, v163, v200 row_newbcast:13 row_mask:0xf bank_mask:0xf
    v_fmac_f32_dpp v193, v163, v201 row_newbcast:13 row_mask:0xf bank_mask:0xf
    v_fmac_f32_dpp v194, v163, v202 row_newbcast:13 row_mask:0xf bank_mask:0xf
    v_fmac_f32_dpp v195, v163, v203 row_newbcast:13 row_mask:0xf bank_mask:0xf
    s_waitcnt vmcnt(5)
    v_lshlrev_b32 v196, 16, v136
    v_and_b32 v197, 0xffff0000, v136
    v_lshlrev_b32 v198, 16, v137
    v_and_b32 v199, 0xffff0000, v137
    v_lshlrev_b32 v200, 16, v138
    v_and_b32 v201, 0xffff0000, v138
    v_lshlrev_b32 v202, 16, v139
    v_and_b32 v203, 0xffff0000, v139
    v_fmac_f32_dpp v164, v160, v196 row_newbcast:14 row_mask:0xf bank_mask:0xf
    v_fmac_f32_dpp v165, v160, v197 row_newbcast:14 row_mask:0xf bank_mask:0xf
    v_fmac_f32_dpp v166, v160, v198 row_newbcast:14 row_mask:0xf bank_mask:0xf
    v_fmac_f32_dpp v167, v160, v199 row_newbcast:14 row_mask:0xf bank_mask:0xf
    v_fmac_f32_dpp v168, v160, v200 row_newbcast:14 row_mask:0xf bank_mask:0xf
    v_fmac_f32_dpp v169, v160, v201 row_newbcast:14 row_mask:0xf bank_mask:0xf
    v_fmac_f32_dpp v170, v160, v202 row_newbcast:14 row_mask:0xf bank_mask:0xf
    v_fmac_f32_dpp v171, v160, v203 row_newbcast:14 row_mask:0xf bank_mask:0xf
    v_fmac_f32_dpp v172, v161, v196 row_newbcast:14 row_mask:0xf bank_mask:0xf
    v_fmac_f32_dpp v173, v161, v197 row_newbcast:14 row_mask:0xf bank_mask:0xf
    v_fmac_f32_dpp v174, v161, v198 row_newbcast:14 row_mask:0xf bank_mask:0xf
    v_fmac_f32_dpp v175, v161, v199 row_newbcast:14 row_mask:0xf bank_mask:0xf
    v_fmac_f32_dpp v176, v161, v200 row_newbcast:14 row_mask:0xf bank_mask:0xf
    v_fmac_f32_dpp v177, v161, v201 row_newbcast:14 row_mask:0xf bank_mask:0xf
    v_fmac_f32_dpp v178, v161, v202 row_newbcast:14 row_mask:0xf bank_mask:0xf
    v_fmac_f32_dpp v179, v161, v203 row_newbcast:14 row_mask:0xf bank_mask:0xf
    v_fmac_f32_dpp v180, v162, v196 row_newbcast:14 row_mask:0xf bank_mask:0xf
    v_fmac_f32_dpp v181, v162, v197 row_newbcast:14 row_mask:0xf bank_mask:0xf
    v_fmac_f32_dpp v182, v162, v198 row_newbcast:14 row_mask:0xf bank_mask:0xf
    v_fmac_f32_dpp v183, v162, v199 row_newbcast:14 row_mask:0xf bank_mask:0xf
    v_fmac_f32_dpp v184, v162, v200 row_newbcast:14 row_mask:0xf bank_mask:0xf
    v_fmac_f32_dpp v185, v162, v201 row_newbcast:14 row_mask:0xf bank_mask:0xf
    v_fmac_f32_dpp v186, v162, v202 row_newbcast:14 row_mask:0xf bank_mask:0xf
    v_fmac_f32_dpp v187, v162, v203 row_newbcast:14 row_mask:0xf bank_mask:0xf
    v_fmac_f32_dpp v188, v163, v196 row_newbcast:14 row_mask:0xf bank_mask:0xf
    v_fmac_f32_dpp v189, v163, v197 row_newbcast:14 row_mask:0xf bank_mask:0xf
    v_fmac_f32_dpp v190, v163, v198 row_newbcast:14 row_mask:0xf bank_mask:0xf
    v_fmac_f32_dpp v191, v163, v199 row_newbcast:14 row_mask:0xf bank_mask:0xf
    v_fmac_f32_dpp v192, v163, v200 row_newbcast:14 row_mask:0xf bank_mask:0xf
    v_fmac_f32_dpp v193, v163, v201 row_newbcast:14 row_mask:0xf bank_mask:0xf
    v_fmac_f32_dpp v194, v163, v202 row_newbcast:14 row_mask:0xf bank_mask:0xf
    v_fmac_f32_dpp v195, v163, v203 row_newbcast:14 row_mask:0xf bank_mask:0xf
    s_waitcnt vmcnt(4)
    v_lshlrev_b32 v196, 16, v140
    v_and_b32 v197, 0xffff0000, v140
    v_lshlrev_b32 v198, 16, v141
    v_and_b32 v199, 0xffff0000, v141
    v_lshlrev_b32 v200, 16, v142
    v_and_b32 v201, 0xffff0000, v142
    v_lshlrev_b32 v202, 16, v143
    v_and_b32 v203, 0xffff0000, v143
    v_fmac_f32_dpp v164, v160, v196 row_newbcast:15 row_mask:0xf bank_mask:0xf
    v_fmac_f32_dpp v165, v160, v197 row_newbcast:15 row_mask:0xf bank_mask:0xf
    v_fmac_f32_dpp v166, v160, v198 row_newbcast:15 row_mask:0xf bank_mask:0xf
    v_fmac_f32_dpp v167, v160, v199 row_newbcast:15 row_mask:0xf bank_mask:0xf
    v_fmac_f32_dpp v168, v160, v200 row_newbcast:15 row_mask:0xf bank_mask:0xf
    v_fmac_f32_dpp v169, v160, v201 row_newbcast:15 row_mask:0xf bank_mask:0xf
    v_fmac_f32_dpp v170, v160, v202 row_newbcast:15 row_mask:0xf bank_mask:0xf
    v_fmac_f32_dpp v171, v160, v203 row_newbcast:15 row_mask:0xf bank_mask:0xf
    v_fmac_f32_dpp v172, v161, v196 row_newbcast:15 row_mask:0xf bank_mask:0xf
    v_fmac_f32_dpp v173, v161, v197 row_newbcast:15 row_mask:0xf bank_mask:0xf
    v_fmac_f32_dpp v174, v161, v198 row_newbcast:15 row_mask:0xf bank_mask:0xf
    v_fmac_f32_dpp v175, v161, v199 row_newbcast:15 row_mask:0xf bank_mask:0xf
    v_fmac_f32_dpp v176, v161, v200 row_newbcast:15 row_mask:0xf bank_mask:0xf
    v_fmac_f32_dpp v177, v161, v201 row_newbcast:15 row_mask:0xf bank_mask:0xf
    v_fmac_f32_dpp v178, v161, v202 row_newbcast:15 row_mask:0xf bank_mask:0xf
    v_fmac_f32_dpp v179, v161, v203 row_newbcast:15 row_mask:0xf bank_mask:0xf
    v_fmac_f32_dpp v180, v162, v196 row_newbcast:15 row_mask:0xf bank_mask:0xf
    v_fmac_f32_dpp v181, v162, v197 row_newbcast:15 row_mask:0xf bank_mask:0xf
    v_fmac_f32_dpp v182, v162, v198 row_newbcast:15 row_mask:0xf bank_mask:0xf
    v_fmac_f32_dpp v183, v162, v199 row_newbcast:15 row_mask:0xf bank_mask:0xf
    v_fmac_f32_dpp v184, v162, v200 row_newbcast:15 row_mask:0xf bank_mask:0xf
    v_fmac_f32_dpp v185, v162, v201 row_newbcast:15 row_mask:0xf bank_mask:0xf
    v_fmac_f32_dpp v186, v162, v202 row_newbcast:15 row_mask:0xf bank_mask:0xf
    v_fmac_f32_dpp v187, v162, v203 row_newbcast:15 row_mask:0xf bank_mask:0xf
    v_fmac_f32_dpp v188, v163, v196 row_newbcast:15 row_mask:0xf bank_mask:0xf
    v_fmac_f32_dpp v189, v163, v197 row_newbcast:15 row_mask:0xf bank_mask:0xf
    v_fmac_f32_dpp v190, v163, v198 row_newbcast:15 row_mask:0xf bank_mask:0xf
    v_fmac_f32_dpp v191, v163, v199 row_newbcast:15 row_mask:0xf bank_mask:0xf
    v_fmac_f32_dpp v192, v163, v200 row_newbcast:15 row_mask:0xf bank_mask:0xf
    v_fmac_f32_dpp v193, v163, v201 row_newbcast:15 row_mask:0xf bank_mask:0xf
    v_fmac_f32_dpp v194, v163, v202 row_newbcast:15 row_mask:0xf bank_mask:0xf
    v_fmac_f32_dpp v195, v163, v203 row_newbcast:15 row_mask:0xf bank_mask:0xf
    v_lshl_add_u32 v206, v252, 2, v253
    v_lshlrev_b32 v206, 11, v206
    v_and_b32 v207, 15, v251
    v_lshl_add_u32 v206, v207, 5, v206
    ds_write_b128 v206, v[164:167] offset:0
    ds_write_b128 v206, v[168:171] offset:16
    ds_write_b128 v206, v[172:175] offset:512
    ds_write_b128 v206, v[176:179] offset:528
    ds_write_b128 v206, v[180:183] offset:1024
    ds_write_b128 v206, v[184:187] offset:1040
    ds_write_b128 v206, v[188:191] offset:1536
    ds_write_b128 v206, v[192:195] offset:1552
    v_mov_b32 v208, v144
    v_mov_b32 v209, v152
    v_cmp_eq_u32 vcc, 1, v251
    s_nop 1
    v_cndmask_b32 v208, v208, v145, vcc
    v_cndmask_b32 v209, v209, v153, vcc
    v_cmp_eq_u32 vcc, 2, v251
    s_nop 1
    v_cndmask_b32 v208, v208, v146, vcc
    v_cndmask_b32 v209, v209, v154, vcc
    v_cmp_eq_u32 vcc, 3, v251
    s_nop 1
    v_cndmask_b32 v208, v208, v147, vcc
    v_cndmask_b32 v209, v209, v155, vcc
    v_lshlrev_b32 v206, 5, v252
    v_lshl_add_u32 v206, v251, 3, v206
    v_add_u32 v206, 0x10000, v206
    v_cmp_gt_u32 vcc, 4, v251
    s_and_saveexec_b64 s[44:45], vcc
    ds_write_b64 v206, v[208:209]
    s_or_b64 exec, exec, s[44:45]
    s_waitcnt lgkmcnt(0)
    s_barrier
    v_lshrrev_b32 v1, 7, v250
    v_lshlrev_b32 v2, 3, v1
    v_add_u32 v2, 0x10000, v2
    ds_read_b64 v[16:17], v2 offset:0
    ds_read_b64 v[18:19], v2 offset:32
    ds_read_b64 v[20:21], v2 offset:64
    ds_read_b64 v[22:23], v2 offset:96
    ds_read_b64 v[24:25], v2 offset:128
    ds_read_b64 v[26:27], v2 offset:160
    ds_read_b64 v[28:29], v2 offset:192
    ds_read_b64 v[30:31], v2 offset:224
    s_waitcnt lgkmcnt(0)
    v_max_f32 v3, v16, v18
    v_max_f32 v3, v3, v20
    v_max_f32 v3, v3, v22
    v_max_f32 v3, v3, v24
    v_max_f32 v3, v3, v26
    v_max_f32 v3, v3, v28
    v_max_f32 v3, v3, v30
    v_sub_f32 v32, v16, v3
    v_sub_f32 v33, v18, v3
    v_sub_f32 v34, v20, v3
    v_sub_f32 v35, v22, v3
    v_sub_f32 v36, v24, v3
    v_sub_f32 v37, v26, v3
    v_sub_f32 v38, v28, v3
    v_sub_f32 v39, v30, v3
    v_exp_f32 v32, v32
    v_exp_f32 v33, v33
    v_exp_f32 v34, v34
    v_exp_f32 v35, v35
    v_exp_f32 v36, v36
    v_exp_f32 v37, v37
    v_exp_f32 v38, v38
    v_exp_f32 v39, v39
    s_nop 0
    v_mul_f32 v4, v32, v17
    v_fmac_f32 v4, v33, v19
    v_fmac_f32 v4, v34, v21
    v_fmac_f32 v4, v35, v23
    v_fmac_f32 v4, v36, v25
    v_fmac_f32 v4, v37, v27
    v_fmac_f32 v4, v38, v29
    v_fmac_f32 v4, v39, v31
    v_lshlrev_b32 v5, 2, v250
    ds_read_b32 v48, v5 offset:0
    ds_read_b32 v49, v5 offset:2048
    ds_read_b32 v50, v5 offset:4096
    ds_read_b32 v51, v5 offset:6144
    s_waitcnt lgkmcnt(0)
    v_add_f32 v48, v48, v49
    v_add_f32 v50, v50, v51
    v_add_f32 v48, v48, v50
    v_mul_f32 v6, v32, v48
    ds_read_b32 v48, v5 offset:8192
    ds_read_b32 v49, v5 offset:10240
    ds_read_b32 v50, v5 offset:12288
    ds_read_b32 v51, v5 offset:14336
    s_waitcnt lgkmcnt(0)
    v_add_f32 v48, v48, v49
    v_add_f32 v50, v50, v51
    v_add_f32 v48, v48, v50
    v_fmac_f32 v6, v33, v48
    ds_read_b32 v48, v5 offset:16384
    ds_read_b32 v49, v5 offset:18432
    ds_read_b32 v50, v5 offset:20480
    ds_read_b32 v51, v5 offset:22528
    s_waitcnt lgkmcnt(0)
    v_add_f32 v48, v48, v49
    v_add_f32 v50, v50, v51
    v_add_f32 v48, v48, v50
    v_fmac_f32 v6, v34, v48
    ds_read_b32 v48, v5 offset:24576
    ds_read_b32 v49, v5 offset:26624
    ds_read_b32 v50, v5 offset:28672
    ds_read_b32 v51, v5 offset:30720
    s_waitcnt lgkmcnt(0)
    v_add_f32 v48, v48, v49
    v_add_f32 v50, v50, v51
    v_add_f32 v48, v48, v50
    v_fmac_f32 v6, v35, v48
    ds_read_b32 v48, v5 offset:32768
    ds_read_b32 v49, v5 offset:34816
    ds_read_b32 v50, v5 offset:36864
    ds_read_b32 v51, v5 offset:38912
    s_waitcnt lgkmcnt(0)
    v_add_f32 v48, v48, v49
    v_add_f32 v50, v50, v51
    v_add_f32 v48, v48, v50
    v_fmac_f32 v6, v36, v48
    ds_read_b32 v48, v5 offset:40960
    ds_read_b32 v49, v5 offset:43008
    ds_read_b32 v50, v5 offset:45056
    ds_read_b32 v51, v5 offset:47104
    s_waitcnt lgkmcnt(0)
    v_add_f32 v48, v48, v49
    v_add_f32 v50, v50, v51
    v_add_f32 v48, v48, v50
    v_fmac_f32 v6, v37, v48
    ds_read_b32 v48, v5 offset:49152
    ds_read_b32 v49, v5 offset:51200
    ds_read_b32 v50, v5 offset:53248
    ds_read_b32 v51, v5 offset:55296
    s_waitcnt lgkmcnt(0)
    v_add_f32 v48, v48, v49
    v_add_f32 v50, v50, v51
    v_add_f32 v48, v48, v50
    v_fmac_f32 v6, v38, v48
    ds_read_b32 v48, v5 offset:57344
    ds_read_b32 v49, v5 offset:59392
    ds_read_b32 v50, v5 offset:61440
    ds_read_b32 v51, v5 offset:63488
    s_waitcnt lgkmcnt(0)
    v_add_f32 v48, v48, v49
    v_add_f32 v50, v50, v51
    v_add_f32 v48, v48, v50
    v_fmac_f32 v6, v39, v48
    v_mov_b32 v7, v254
    s_lshl_b32 s34, s2, 12
    s_add_u32 s34, s34, 1048576
    v_lshl_add_u32 v5, v5, 1, s34
    global_store_dwordx2 v5, v[6:7], s[14:15] sc1
    v_and_b32 v8, 127, v250
    v_cmp_eq_u32 vcc, 0, v8
    s_and_saveexec_b64 s[44:45], vcc
    s_cbranch_execz L_mld
    s_lshl_b32 s34, s2, 6
    s_add_u32 s34, s34, 2097152
    v_lshl_add_u32 v8, v1, 4, s34
    v_mov_b32 v12, v3
    v_mov_b32 v13, v254
    v_mov_b32 v14, v4
    v_mov_b32 v15, v254
    global_store_dwordx4 v8, v[12:15], s[14:15] sc1
L_mld:
    s_or_b64 exec, exec, s[44:45]
    s_cmp_ge_u32 s2, 112
    s_cbranch_scc1 L_noB
    v_lshrrev_b32 v1, 7, v250
    s_movk_i32 s34, 1792*8
    v_mul_lo_u32 v2, v1, s34
    v_and_b32 v3, 127, v250
    v_lshl_add_u32 v2, v3, 3, v2
    s_lshl_b32 s34, s26, 10
    s_add_u32 s34, s34, 528384
    v_add_u32 v2, s34, v2
    s_mov_b32 s40, 0
L_spin1:
    global_load_dwordx2 v[16:17], v2, s[14:15] sc1
    v_add_u32 v2, 57344, v2
    global_load_dwordx2 v[18:19], v2, s[14:15] sc1
    v_add_u32 v2, 57344, v2
    global_load_dwordx2 v[20:21], v2, s[14:15] sc1
    v_add_u32 v2, 57344, v2
    global_load_dwordx2 v[22:23], v2, s[14:15] sc1
    v_add_u32 v2, 57344, v2
    global_load_dwordx2 v[24:25], v2, s[14:15] sc1
    v_add_u32 v2, 57344, v2
    global_load_dwordx2 v[26:27], v2, s[14:15] sc1
    v_add_u32 v2, 57344, v2
    global_load_dwordx2 v[28:29], v2, s[14:15] sc1
    v_add_u32 v2, 57344, v2
    global_load_dwordx2 v[30:31], v2, s[14:15] sc1
    v_subrev_u32 v2, 401408, v2
    s_waitcnt vmcnt(0)
    v_xor_b32 v207, v17, v254
    v_xor_b32 v208, v19, v254
    v_or_b32 v207, v207, v208
    v_xor_b32 v208, v21, v254
    v_or_b32 v207, v207, v208
    v_xor_b32 v208, v23, v254
    v_or_b32 v207, v207, v208
    v_xor_b32 v208, v25, v254
    v_or_b32 v207, v207, v208
    v_xor_b32 v208, v27, v254
    v_or_b32 v207, v207, v208
    v_xor_b32 v208, v29, v254
    v_or_b32 v207, v207, v208
    v_xor_b32 v208, v31, v254
    v_or_b32 v207, v207, v208
    v_cmp_ne_u32 vcc, 0, v207
    s_cbranch_vccz L_spind1
    s_sleep 1
    s_add_u32 s40, s40, 1
    s_cmp_lt_u32 s40, 200000
    s_cbranch_scc1 L_spin1
L_spind1:
    v_add_f32 v16, v16, v18
    v_add_f32 v20, v20, v22
    v_add_f32 v16, v16, v20
    v_add_f32 v24, v24, v26
    v_add_f32 v28, v28, v30
    v_add_f32 v24, v24, v28
    v_cvt_pk_bf16_f32 v16, v16, v24
    v_and_b32 v24, 0xffff0000, v16
    v_lshlrev_b32 v16, 16, v16
    v_max_f32 v16, 0, v16
    v_mul_f32 v16, v16, v24
    v_cvt_pk_bf16_f32 v16, v16, v16
    v_lshlrev_b32 v16, 16, v16
    s_barrier
    v_lshlrev_b32 v2, 4, v3
    v_lshl_add_u32 v2, v1, 2, v2
    ds_write_b32 v2, v16
    s_waitcnt lgkmcnt(0)
    s_add_u32 s53, s26, 32
    s_barrier
    v_lshlrev_b32 v206, 4, v204
    ds_read_b128 v[144:147], v206 offset:0
    ds_read_b128 v[148:151], v206 offset:128
    s_waitcnt lgkmcnt(0)
    v_lshlrev_b32 v196, 16, v224
    v_and_b32 v197, 0xffff0000, v224
    v_lshlrev_b32 v198, 16, v225
    v_and_b32 v199, 0xffff0000, v225
    v_lshlrev_b32 v200, 16, v226
    v_and_b32 v201, 0xffff0000, v226
    v_lshlrev_b32 v202, 16, v227
    v_and_b32 v203, 0xffff0000, v227
    v_mul_f32 v164, v144, v196
    v_mul_f32 v165, v144, v197
    v_mul_f32 v166, v144, v198
    v_mul_f32 v167, v144, v199
    v_mul_f32 v168, v144, v200
    v_mul_f32 v169, v144, v201
    v_mul_f32 v170, v144, v202
    v_mul_f32 v171, v144, v203
    v_mul_f32 v172, v145, v196
    v_mul_f32 v173, v145, v197
    v_mul_f32 v174, v145, v198
    v_mul_f32 v175, v145, v199
    v_mul_f32 v176, v145, v200
    v_mul_f32 v177, v145, v201
    v_mul_f32 v178, v145, v202
    v_mul_f32 v179, v145, v203
    v_mul_f32 v180, v146, v196
    v_mul_f32 v181, v146, v197
    v_mul_f32 v182, v146, v198
    v_mul_f32 v183, v146, v199
    v_mul_f32 v184, v146, v200
    v_mul_f32 v185, v146, v201
    v_mul_f32 v186, v146, v202
    v_mul_f32 v187, v146, v203
    v_mul_f32 v188, v147, v196
    v_mul_f32 v189, v147, v197
    v_mul_f32 v190, v147, v198
    v_mul_f32 v191, v147, v199
    v_mul_f32 v192, v147, v200
    v_mul_f32 v193, v147, v201
    v_mul_f32 v194, v147, v202
    v_mul_f32 v195, v147, v203
    v_lshlrev_b32 v196, 16, v228
    v_and_b32 v197, 0xffff0000, v228
    v_lshlrev_b32 v198, 16, v229
    v_and_b32 v199, 0xffff0000, v229
    v_lshlrev_b32 v200, 16, v230
    v_and_b32 v201, 0xffff0000, v230
    v_lshlrev_b32 v202, 16, v231
    v_and_b32 v203, 0xffff0000, v231
    v_fmac_f32 v164, v148, v196
    v_fmac_f32 v165, v148, v197
    v_fmac_f32 v166, v148, v198
    v_fmac_f32 v167, v148, v199
    v_fmac_f32 v168, v148, v200
    v_fmac_f32 v169, v148, v201
    v_fmac_f32 v170, v148, v202
    v_fmac_f32 v171, v148, v203
    v_fmac_f32 v172, v149, v196
    v_fmac_f32 v173, v149, v197
    v_fmac_f32 v174, v149, v198
    v_fmac_f32 v175, v149, v199
    v_fmac_f32 v176, v149, v200
    v_fmac_f32 v177, v149, v201
    v_fmac_f32 v178, v149, v202
    v_fmac_f32 v179, v149, v203
    v_fmac_f32 v180, v150, v196
    v_fmac_f32 v181, v150, v197
    v_fmac_f32 v182, v150, v198
    v_fmac_f32 v183, v150, v199
    v_fmac_f32 v184, v150, v200
    v_fmac_f32 v185, v150, v201
    v_fmac_f32 v186, v150, v202
    v_fmac_f32 v187, v150, v203
    v_fmac_f32 v188, v151, v196
    v_fmac_f32 v189, v151, v197
    v_fmac_f32 v190, v151, v198
    v_fmac_f32 v191, v151, v199
    v_fmac_f32 v192, v151, v200
    v_fmac_f32 v193, v151, v201
    v_fmac_f32 v194, v151, v202
    v_fmac_f32 v195, v151, v203
    v_lshrrev_b32 v206, 3, v250
    v_lshlrev_b32 v206, 10, v206
    v_lshl_add_u32 v206, v205, 1, v206
    ds_write_b128 v206, v[164:167] offset:8192
    ds_write_b128 v206, v[168:171] offset:8208
    ds_write_b128 v206, v[172:175] offset:8448
    ds_write_b128 v206, v[176:179] offset:8464
    ds_write_b128 v206, v[180:183] offset:8704
    ds_write_b128 v206, v[184:187] offset:8720
    ds_write_b128 v206, v[188:191] offset:8960
    ds_write_b128 v206, v[192:195] offset:8976
    s_waitcnt lgkmcnt(0)
    s_barrier
    v_cmp_gt_u32 vcc, 256, v250
    s_and_saveexec_b64 s[44:45], vcc
    s_cbranch_execz L_tB
    v_lshlrev_b32 v206, 2, v250
    v_add_u32 v206, 0x2000, v206
    ds_read_b32 v144, v206 offset:0
    ds_read_b32 v145, v206 offset:1024
    ds_read_b32 v146, v206 offset:2048
    ds_read_b32 v147, v206 offset:3072
    ds_read_b32 v148, v206 offset:4096
    ds_read_b32 v149, v206 offset:5120
    ds_read_b32 v150, v206 offset:6144
    ds_read_b32 v151, v206 offset:7168
    s_waitcnt lgkmcnt(0)
    v_mov_b32 v208, v144
    v_add_f32 v208, v208, v145
    v_add_f32 v208, v208, v146
    v_add_f32 v208, v208, v147
    v_add_f32 v208, v208, v148
    v_add_f32 v208, v208, v149
    v_add_f32 v208, v208, v150
    v_add_f32 v208, v208, v151
    ds_read_b32 v144, v206 offset:8192
    ds_read_b32 v145, v206 offset:9216
    ds_read_b32 v146, v206 offset:10240
    ds_read_b32 v147, v206 offset:11264
    ds_read_b32 v148, v206 offset:12288
    ds_read_b32 v149, v206 offset:13312
    ds_read_b32 v150, v206 offset:14336
    ds_read_b32 v151, v206 offset:15360
    s_waitcnt lgkmcnt(0)
    v_add_f32 v208, v208, v144
    v_add_f32 v208, v208, v145
    v_add_f32 v208, v208, v146
    v_add_f32 v208, v208, v147
    v_add_f32 v208, v208, v148
    v_add_f32 v208, v208, v149
    v_add_f32 v208, v208, v150
    v_add_f32 v208, v208, v151
    ds_read_b32 v144, v206 offset:16384
    ds_read_b32 v145, v206 offset:17408
    ds_read_b32 v146, v206 offset:18432
    ds_read_b32 v147, v206 offset:19456
    ds_read_b32 v148, v206 offset:20480
    ds_read_b32 v149, v206 offset:21504
    ds_read_b32 v150, v206 offset:22528
    ds_read_b32 v151, v206 offset:23552
    s_waitcnt lgkmcnt(0)
    v_add_f32 v208, v208, v144
    v_add_f32 v208, v208, v145
    v_add_f32 v208, v208, v146
    v_add_f32 v208, v208, v147
    v_add_f32 v208, v208, v148
    v_add_f32 v208, v208, v149
    v_add_f32 v208, v208, v150
    v_add_f32 v208, v208, v151
    ds_read_b32 v144, v206 offset:24576
    ds_read_b32 v145, v206 offset:25600
    ds_read_b32 v146, v206 offset:26624
    ds_read_b32 v147, v206 offset:27648
    ds_read_b32 v148, v206 offset:28672
    ds_read_b32 v149, v206 offset:29696
    ds_read_b32 v150, v206 offset:30720
    ds_read_b32 v151, v206 offset:31744
    s_waitcnt lgkmcnt(0)
    v_add_f32 v208, v208, v144
    v_add_f32 v208, v208, v145
    v_add_f32 v208, v208, v146
    v_add_f32 v208, v208, v147
    v_add_f32 v208, v208, v148
    v_add_f32 v208, v208, v149
    v_add_f32 v208, v208, v150
    v_add_f32 v208, v208, v151
    ds_read_b32 v144, v206 offset:32768
    ds_read_b32 v145, v206 offset:33792
    ds_read_b32 v146, v206 offset:34816
    ds_read_b32 v147, v206 offset:35840
    ds_read_b32 v148, v206 offset:36864
    ds_read_b32 v149, v206 offset:37888
    ds_read_b32 v150, v206 offset:38912
    ds_read_b32 v151, v206 offset:39936
    s_waitcnt lgkmcnt(0)
    v_add_f32 v208, v208, v144
    v_add_f32 v208, v208, v145
    v_add_f32 v208, v208, v146
    v_add_f32 v208, v208, v147
    v_add_f32 v208, v208, v148
    v_add_f32 v208, v208, v149
    v_add_f32 v208, v208, v150
    v_add_f32 v208, v208, v151
    ds_read_b32 v144, v206 offset:40960
    ds_read_b32 v145, v206 offset:41984
    ds_read_b32 v146, v206 offset:43008
    ds_read_b32 v147, v206 offset:44032
    ds_read_b32 v148, v206 offset:45056
    ds_read_b32 v149, v206 offset:46080
    ds_read_b32 v150, v206 offset:47104
    ds_read_b32 v151, v206 offset:48128
    s_waitcnt lgkmcnt(0)
    v_add_f32 v208, v208, v144
    v_add_f32 v208, v208, v145
    v_add_f32 v208, v208, v146
    v_add_f32 v208, v208, v147
    v_add_f32 v208, v208, v148
    v_add_f32 v208, v208, v149
    v_add_f32 v208, v208, v150
    v_add_f32 v208, v208, v151
    ds_read_b32 v144, v206 offset:49152
    ds_read_b32 v145, v206 offset:50176
    ds_read_b32 v146, v206 offset:51200
    ds_read_b32 v147, v206 offset:52224
    ds_read_b32 v148, v206 offset:53248
    ds_read_b32 v149, v206 offset:54272
    ds_read_b32 v150, v206 offset:55296
    ds_read_b32 v151, v206 offset:56320
    s_waitcnt lgkmcnt(0)
    v_add_f32 v208, v208, v144
    v_add_f32 v208, v208, v145
    v_add_f32 v208, v208, v146
    v_add_f32 v208, v208, v147
    v_add_f32 v208, v208, v148
    v_add_f32 v208, v208, v149
    v_add_f32 v208, v208, v150
    v_add_f32 v208, v208, v151
    ds_read_b32 v144, v206 offset:57344
    ds_read_b32 v145, v206 offset:58368
    ds_read_b32 v146, v206 offset:59392
    ds_read_b32 v147, v206 offset:60416
    ds_read_b32 v148, v206 offset:61440
    ds_read_b32 v149, v206 offset:62464
    ds_read_b32 v150, v206 offset:63488
    ds_read_b32 v151, v206 offset:64512
    s_waitcnt lgkmcnt(0)
    v_add_f32 v208, v208, v144
    v_add_f32 v208, v208, v145
    v_add_f32 v208, v208, v146
    v_add_f32 v208, v208, v147
    v_add_f32 v208, v208, v148
    v_add_f32 v208, v208, v149
    v_add_f32 v208, v208, v150
    v_add_f32 v208, v208, v151
    v_mov_b32 v209, v254
    s_lshl_b32 s34, s53, 14
    s_lshl_b32 s35, s27, 9
    s_add_u32 s34, s34, s35
    s_add_u32 s34, s34, 2162688
    v_lshrrev_b32 v210, 6, v250
    v_lshlrev_b32 v210, 12, v210
    v_and_b32 v211, 63, v250
    v_lshl_add_u32 v210, v211, 3, v210
    v_add_u32 v210, s34, v210
    global_store_dwordx2 v210, v[208:209], s[14:15] sc1
L_tB:
    s_or_b64 exec, exec, s[44:45]
L_noB:
    v_lshrrev_b32 v1, 7, v250
    v_and_b32 v3, 127, v250
    s_lshr_b32 s34, s26, 2
    s_and_b32 s35, s26, 3
    s_lshl_b32 s34, s34, 15
    s_lshl_b32 s36, s35, 10
    s_add_u32 s34, s34, s36
    s_add_u32 s34, s34, 1048576
    v_lshlrev_b32 v2, 18, v1
    v_lshl_add_u32 v2, v3, 3, v2
    v_add_u32 v2, s34, v2
    s_lshr_b32 s34, s26, 2
    s_lshl_b32 s34, s34, 9
    s_lshl_b32 s36, s35, 4
    s_add_u32 s34, s34, s36
    s_add_u32 s34, s34, 2097152
    v_lshlrev_b32 v4, 12, v1
    v_add_u32 v4, s34, v4
    s_mov_b32 s40, 0
L_spin2:
    global_load_dwordx2 v[16:17], v2, s[14:15] offset:0 sc1
    global_load_dwordx4 v[32:35], v4, s[14:15] offset:0 sc1
    v_add_u32 v2, 0x1000, v2
    global_load_dwordx2 v[18:19], v2, s[14:15] offset:0 sc1
    global_load_dwordx4 v[36:39], v4, s[14:15] offset:64 sc1
    v_add_u32 v2, 0x1000, v2
    global_load_dwordx2 v[20:21], v2, s[14:15] offset:0 sc1
    global_load_dwordx4 v[40:43], v4, s[14:15] offset:128 sc1
    v_add_u32 v2, 0x1000, v2
    global_load_dwordx2 v[22:23], v2, s[14:15] offset:0 sc1
    global_load_dwordx4 v[44:47], v4, s[14:15] offset:192 sc1
    v_add_u32 v2, 0x1000, v2
    global_load_dwordx2 v[24:25], v2, s[14:15] offset:0 sc1
    global_load_dwordx4 v[48:51], v4, s[14:15] offset:256 sc1
    v_add_u32 v2, 0x1000, v2
    global_load_dwordx2 v[26:27], v2, s[14:15] offset:0 sc1
    global_load_dwordx4 v[52:55], v4, s[14:15] offset:320 sc1
    v_add_u32 v2, 0x1000, v2
    global_load_dwordx2 v[28:29], v2, s[14:15] offset:0 sc1
    global_load_dwordx4 v[56:59], v4, s[14:15] offset:384 sc1
    v_add_u32 v2, 0x1000, v2
    global_load_dwordx2 v[30:31], v2, s[14:15] offset:0 sc1
    global_load_dwordx4 v[60:63], v4, s[14:15] offset:448 sc1
    v_subrev_u32 v2, 0x7000, v2
    s_waitcnt vmcnt(0)
    v_xor_b32 v207, v17, v254
    v_xor_b32 v208, v19, v254
    v_or_b32 v207, v207, v208
    v_xor_b32 v208, v21, v254
    v_or_b32 v207, v207, v208
    v_xor_b32 v208, v23, v254
    v_or_b32 v207, v207, v208
    v_xor_b32 v208, v25, v254
    v_or_b32 v207, v207, v208
    v_xor_b32 v208, v27, v254
    v_or_b32 v207, v207, v208
    v_xor_b32 v208, v29, v254
    v_or_b32 v207, v207, v208
    v_xor_b32 v208, v31, v254
    v_or_b32 v207, v207, v208
    v_xor_b32 v208, v33, v254
    v_or_b32 v207, v207, v208
    v_xor_b32 v208, v37, v254
    v_or_b32 v207, v207, v208
    v_xor_b32 v208, v41, v254
    v_or_b32 v207, v207, v208
    v_xor_b32 v208, v45, v254
    v_or_b32 v207, v207, v208
    v_xor_b32 v208, v49, v254
    v_or_b32 v207, v207, v208
    v_xor_b32 v208, v53, v254
    v_or_b32 v207, v207, v208
    v_xor_b32 v208, v57, v254
    v_or_b32 v207, v207, v208
    v_xor_b32 v208, v61, v254
    v_or_b32 v207, v207, v208
    v_xor_b32 v208, v35, v254
    v_or_b32 v207, v207, v208
    v_xor_b32 v208, v39, v254
    v_or_b32 v207, v207, v208
    v_xor_b32 v208, v43, v254
    v_or_b32 v207, v207, v208
    v_xor_b32 v208, v47, v254
    v_or_b32 v207, v207, v208
    v_xor_b32 v208, v51, v254
    v_or_b32 v207, v207, v208
    v_xor_b32 v208, v55, v254
    v_or_b32 v207, v207, v208
    v_xor_b32 v208, v59, v254
    v_or_b32 v207, v207, v208
    v_xor_b32 v208, v63, v254
    v_or_b32 v207, v207, v208
    v_cmp_ne_u32 vcc, 0, v207
    s_cbranch_vccz L_spind2
    s_sleep 1
    s_add_u32 s40, s40, 1
    s_cmp_lt_u32 s40, 200000
    s_cbranch_scc1 L_spin2
L_spind2:
    v_max_f32 v5, v32, v36
    v_max_f32 v5, v5, v40
    v_max_f32 v5, v5, v44
    v_max_f32 v5, v5, v48
    v_max_f32 v5, v5, v52
    v_max_f32 v5, v5, v56
    v_max_f32 v5, v5, v60
    v_sub_f32 v64, v32, v5
    v_sub_f32 v65, v36, v5
    v_sub_f32 v66, v40, v5
    v_sub_f32 v67, v44, v5
    v_sub_f32 v68, v48, v5
    v_sub_f32 v69, v52, v5
    v_sub_f32 v70, v56, v5
    v_sub_f32 v71, v60, v5
    v_exp_f32 v64, v64
    v_exp_f32 v65, v65
    v_exp_f32 v66, v66
    v_exp_f32 v67, v67
    v_exp_f32 v68, v68
    v_exp_f32 v69, v69
    v_exp_f32 v70, v70
    v_exp_f32 v71, v71
    s_nop 0
    v_mul_f32 v6, v64, v34
    v_mul_f32 v7, v64, v16
    v_fmac_f32 v6, v65, v38
    v_fmac_f32 v7, v65, v18
    v_fmac_f32 v6, v66, v42
    v_fmac_f32 v7, v66, v20
    v_fmac_f32 v6, v67, v46
    v_fmac_f32 v7, v67, v22
    v_fmac_f32 v6, v68, v50
    v_fmac_f32 v7, v68, v24
    v_fmac_f32 v6, v69, v54
    v_fmac_f32 v7, v69, v26
    v_fmac_f32 v6, v70, v58
    v_fmac_f32 v7, v70, v28
    v_fmac_f32 v6, v71, v62
    v_fmac_f32 v7, v71, v30
    v_rcp_f32 v6, v6
    s_nop 0
    v_mul_f32 v7, v7, v6
    v_cvt_pk_bf16_f32 v7, v7, v7
    v_lshlrev_b32 v7, 16, v7
    s_barrier
    v_lshlrev_b32 v2, 4, v3
    v_lshl_add_u32 v2, v1, 2, v2
    ds_write_b32 v2, v7
    s_waitcnt lgkmcnt(0)
    s_barrier
    v_lshlrev_b32 v206, 4, v204
    ds_read_b128 v[144:147], v206 offset:0
    ds_read_b128 v[148:151], v206 offset:128
    s_waitcnt lgkmcnt(0)
    v_lshlrev_b32 v196, 16, v232
    v_and_b32 v197, 0xffff0000, v232
    v_lshlrev_b32 v198, 16, v233
    v_and_b32 v199, 0xffff0000, v233
    v_lshlrev_b32 v200, 16, v234
    v_and_b32 v201, 0xffff0000, v234
    v_lshlrev_b32 v202, 16, v235
    v_and_b32 v203, 0xffff0000, v235
    v_mul_f32 v164, v144, v196
    v_mul_f32 v165, v144, v197
    v_mul_f32 v166, v144, v198
    v_mul_f32 v167, v144, v199
    v_mul_f32 v168, v144, v200
    v_mul_f32 v169, v144, v201
    v_mul_f32 v170, v144, v202
    v_mul_f32 v171, v144, v203
    v_mul_f32 v172, v145, v196
    v_mul_f32 v173, v145, v197
    v_mul_f32 v174, v145, v198
    v_mul_f32 v175, v145, v199
    v_mul_f32 v176, v145, v200
    v_mul_f32 v177, v145, v201
    v_mul_f32 v178, v145, v202
    v_mul_f32 v179, v145, v203
    v_mul_f32 v180, v146, v196
    v_mul_f32 v181, v146, v197
    v_mul_f32 v182, v146, v198
    v_mul_f32 v183, v146, v199
    v_mul_f32 v184, v146, v200
    v_mul_f32 v185, v146, v201
    v_mul_f32 v186, v146, v202
    v_mul_f32 v187, v146, v203
    v_mul_f32 v188, v147, v196
    v_mul_f32 v189, v147, v197
    v_mul_f32 v190, v147, v198
    v_mul_f32 v191, v147, v199
    v_mul_f32 v192, v147, v200
    v_mul_f32 v193, v147, v201
    v_mul_f32 v194, v147, v202
    v_mul_f32 v195, v147, v203
    v_lshlrev_b32 v196, 16, v236
    v_and_b32 v197, 0xffff0000, v236
    v_lshlrev_b32 v198, 16, v237
    v_and_b32 v199, 0xffff0000, v237
    v_lshlrev_b32 v200, 16, v238
    v_and_b32 v201, 0xffff0000, v238
    v_lshlrev_b32 v202, 16, v239
    v_and_b32 v203, 0xffff0000, v239
    v_fmac_f32 v164, v148, v196
    v_fmac_f32 v165, v148, v197
    v_fmac_f32 v166, v148, v198
    v_fmac_f32 v167, v148, v199
    v_fmac_f32 v168, v148, v200
    v_fmac_f32 v169, v148, v201
    v_fmac_f32 v170, v148, v202
    v_fmac_f32 v171, v148, v203
    v_fmac_f32 v172, v149, v196
    v_fmac_f32 v173, v149, v197
    v_fmac_f32 v174, v149, v198
    v_fmac_f32 v175, v149, v199
    v_fmac_f32 v176, v149, v200
    v_fmac_f32 v177, v149, v201
    v_fmac_f32 v178, v149, v202
    v_fmac_f32 v179, v149, v203
    v_fmac_f32 v180, v150, v196
    v_fmac_f32 v181, v150, v197
    v_fmac_f32 v182, v150, v198
    v_fmac_f32 v183, v150, v199
    v_fmac_f32 v184, v150, v200
    v_fmac_f32 v185, v150, v201
    v_fmac_f32 v186, v150, v202
    v_fmac_f32 v187, v150, v203
    v_fmac_f32 v188, v151, v196
    v_fmac_f32 v189, v151, v197
    v_fmac_f32 v190, v151, v198
    v_fmac_f32 v191, v151, v199
    v_fmac_f32 v192, v151, v200
    v_fmac_f32 v193, v151, v201
    v_fmac_f32 v194, v151, v202
    v_fmac_f32 v195, v151, v203
    v_lshrrev_b32 v206, 3, v250
    v_lshlrev_b32 v206, 10, v206
    v_lshl_add_u32 v206, v205, 1, v206
    ds_write_b128 v206, v[164:167] offset:8192
    ds_write_b128 v206, v[168:171] offset:8208
    ds_write_b128 v206, v[172:175] offset:8448
    ds_write_b128 v206, v[176:179] offset:8464
    ds_write_b128 v206, v[180:183] offset:8704
    ds_write_b128 v206, v[184:187] offset:8720
    ds_write_b128 v206, v[188:191] offset:8960
    ds_write_b128 v206, v[192:195] offset:8976
    s_waitcnt lgkmcnt(0)
    s_barrier
    v_cmp_gt_u32 vcc, 256, v250
    s_and_saveexec_b64 s[44:45], vcc
    s_cbranch_execz L_tA
    v_lshlrev_b32 v206, 2, v250
    v_add_u32 v206, 0x2000, v206
    ds_read_b32 v144, v206 offset:0
    ds_read_b32 v145, v206 offset:1024
    ds_read_b32 v146, v206 offset:2048
    ds_read_b32 v147, v206 offset:3072
    ds_read_b32 v148, v206 offset:4096
    ds_read_b32 v149, v206 offset:5120
    ds_read_b32 v150, v206 offset:6144
    ds_read_b32 v151, v206 offset:7168
    s_waitcnt lgkmcnt(0)
    v_mov_b32 v208, v144
    v_add_f32 v208, v208, v145
    v_add_f32 v208, v208, v146
    v_add_f32 v208, v208, v147
    v_add_f32 v208, v208, v148
    v_add_f32 v208, v208, v149
    v_add_f32 v208, v208, v150
    v_add_f32 v208, v208, v151
    ds_read_b32 v144, v206 offset:8192
    ds_read_b32 v145, v206 offset:9216
    ds_read_b32 v146, v206 offset:10240
    ds_read_b32 v147, v206 offset:11264
    ds_read_b32 v148, v206 offset:12288
    ds_read_b32 v149, v206 offset:13312
    ds_read_b32 v150, v206 offset:14336
    ds_read_b32 v151, v206 offset:15360
    s_waitcnt lgkmcnt(0)
    v_add_f32 v208, v208, v144
    v_add_f32 v208, v208, v145
    v_add_f32 v208, v208, v146
    v_add_f32 v208, v208, v147
    v_add_f32 v208, v208, v148
    v_add_f32 v208, v208, v149
    v_add_f32 v208, v208, v150
    v_add_f32 v208, v208, v151
    ds_read_b32 v144, v206 offset:16384
    ds_read_b32 v145, v206 offset:17408
    ds_read_b32 v146, v206 offset:18432
    ds_read_b32 v147, v206 offset:19456
    ds_read_b32 v148, v206 offset:20480
    ds_read_b32 v149, v206 offset:21504
    ds_read_b32 v150, v206 offset:22528
    ds_read_b32 v151, v206 offset:23552
    s_waitcnt lgkmcnt(0)
    v_add_f32 v208, v208, v144
    v_add_f32 v208, v208, v145
    v_add_f32 v208, v208, v146
    v_add_f32 v208, v208, v147
    v_add_f32 v208, v208, v148
    v_add_f32 v208, v208, v149
    v_add_f32 v208, v208, v150
    v_add_f32 v208, v208, v151
    ds_read_b32 v144, v206 offset:24576
    ds_read_b32 v145, v206 offset:25600
    ds_read_b32 v146, v206 offset:26624
    ds_read_b32 v147, v206 offset:27648
    ds_read_b32 v148, v206 offset:28672
    ds_read_b32 v149, v206 offset:29696
    ds_read_b32 v150, v206 offset:30720
    ds_read_b32 v151, v206 offset:31744
    s_waitcnt lgkmcnt(0)
    v_add_f32 v208, v208, v144
    v_add_f32 v208, v208, v145
    v_add_f32 v208, v208, v146
    v_add_f32 v208, v208, v147
    v_add_f32 v208, v208, v148
    v_add_f32 v208, v208, v149
    v_add_f32 v208, v208, v150
    v_add_f32 v208, v208, v151
    ds_read_b32 v144, v206 offset:32768
    ds_read_b32 v145, v206 offset:33792
    ds_read_b32 v146, v206 offset:34816
    ds_read_b32 v147, v206 offset:35840
    ds_read_b32 v148, v206 offset:36864
    ds_read_b32 v149, v206 offset:37888
    ds_read_b32 v150, v206 offset:38912
    ds_read_b32 v151, v206 offset:39936
    s_waitcnt lgkmcnt(0)
    v_add_f32 v208, v208, v144
    v_add_f32 v208, v208, v145
    v_add_f32 v208, v208, v146
    v_add_f32 v208, v208, v147
    v_add_f32 v208, v208, v148
    v_add_f32 v208, v208, v149
    v_add_f32 v208, v208, v150
    v_add_f32 v208, v208, v151
    ds_read_b32 v144, v206 offset:40960
    ds_read_b32 v145, v206 offset:41984
    ds_read_b32 v146, v206 offset:43008
    ds_read_b32 v147, v206 offset:44032
    ds_read_b32 v148, v206 offset:45056
    ds_read_b32 v149, v206 offset:46080
    ds_read_b32 v150, v206 offset:47104
    ds_read_b32 v151, v206 offset:48128
    s_waitcnt lgkmcnt(0)
    v_add_f32 v208, v208, v144
    v_add_f32 v208, v208, v145
    v_add_f32 v208, v208, v146
    v_add_f32 v208, v208, v147
    v_add_f32 v208, v208, v148
    v_add_f32 v208, v208, v149
    v_add_f32 v208, v208, v150
    v_add_f32 v208, v208, v151
    ds_read_b32 v144, v206 offset:49152
    ds_read_b32 v145, v206 offset:50176
    ds_read_b32 v146, v206 offset:51200
    ds_read_b32 v147, v206 offset:52224
    ds_read_b32 v148, v206 offset:53248
    ds_read_b32 v149, v206 offset:54272
    ds_read_b32 v150, v206 offset:55296
    ds_read_b32 v151, v206 offset:56320
    s_waitcnt lgkmcnt(0)
    v_add_f32 v208, v208, v144
    v_add_f32 v208, v208, v145
    v_add_f32 v208, v208, v146
    v_add_f32 v208, v208, v147
    v_add_f32 v208, v208, v148
    v_add_f32 v208, v208, v149
    v_add_f32 v208, v208, v150
    v_add_f32 v208, v208, v151
    ds_read_b32 v144, v206 offset:57344
    ds_read_b32 v145, v206 offset:58368
    ds_read_b32 v146, v206 offset:59392
    ds_read_b32 v147, v206 offset:60416
    ds_read_b32 v148, v206 offset:61440
    ds_read_b32 v149, v206 offset:62464
    ds_read_b32 v150, v206 offset:63488
    ds_read_b32 v151, v206 offset:64512
    s_waitcnt lgkmcnt(0)
    v_add_f32 v208, v208, v144
    v_add_f32 v208, v208, v145
    v_add_f32 v208, v208, v146
    v_add_f32 v208, v208, v147
    v_add_f32 v208, v208, v148
    v_add_f32 v208, v208, v149
    v_add_f32 v208, v208, v150
    v_add_f32 v208, v208, v151
    v_mov_b32 v209, v254
    s_lshl_b32 s34, s26, 14
    s_lshl_b32 s35, s27, 9
    s_add_u32 s34, s34, s35
    s_add_u32 s34, s34, 2162688
    v_lshrrev_b32 v210, 6, v250
    v_lshlrev_b32 v210, 12, v210
    v_and_b32 v211, 63, v250
    v_lshl_add_u32 v210, v211, 3, v210
    v_add_u32 v210, s34, v210
    global_store_dwordx2 v210, v[208:209], s[14:15] sc1
L_tA:
    s_or_b64 exec, exec, s[44:45]
    s_cmp_lt_u32 s2, 248
    s_cbranch_scc1 L_end
    v_lshlrev_b32 v1, 4, v251
    global_load_dwordx4 v[32:35], v1, s[22:23]
    v_and_b32 v2, 3, v252
    v_lshl_add_u32 v2, v2, 10, v1
    global_load_dwordx4 v[36:39], v2, s[4:5]
    s_waitcnt vmcnt(0)
    v_mov_b32 v40, 0
    v_lshlrev_b32 v41, 16, v32
    v_lshlrev_b32 v42, 16, v36
    v_mul_f32 v41, v41, v42
    v_and_b32 v43, 0xffff0000, v32
    v_and_b32 v44, 0xffff0000, v36
    v_mul_f32 v43, v43, v44
    v_cvt_pk_bf16_f32 v41, v41, v43
    v_lshlrev_b32 v42, 16, v41
    v_and_b32 v43, 0xffff0000, v41
    v_add_f32 v40, v40, v42
    v_add_f32 v40, v40, v43
    v_lshlrev_b32 v41, 16, v33
    v_lshlrev_b32 v42, 16, v37
    v_mul_f32 v41, v41, v42
    v_and_b32 v43, 0xffff0000, v33
    v_and_b32 v44, 0xffff0000, v37
    v_mul_f32 v43, v43, v44
    v_cvt_pk_bf16_f32 v41, v41, v43
    v_lshlrev_b32 v42, 16, v41
    v_and_b32 v43, 0xffff0000, v41
    v_add_f32 v40, v40, v42
    v_add_f32 v40, v40, v43
    v_lshlrev_b32 v41, 16, v34
    v_lshlrev_b32 v42, 16, v38
    v_mul_f32 v41, v41, v42
    v_and_b32 v43, 0xffff0000, v34
    v_and_b32 v44, 0xffff0000, v38
    v_mul_f32 v43, v43, v44
    v_cvt_pk_bf16_f32 v41, v41, v43
    v_lshlrev_b32 v42, 16, v41
    v_and_b32 v43, 0xffff0000, v41
    v_add_f32 v40, v40, v42
    v_add_f32 v40, v40, v43
    v_lshlrev_b32 v41, 16, v35
    v_lshlrev_b32 v42, 16, v39
    v_mul_f32 v41, v41, v42
    v_and_b32 v43, 0xffff0000, v35
    v_and_b32 v44, 0xffff0000, v39
    v_mul_f32 v43, v43, v44
    v_cvt_pk_bf16_f32 v41, v41, v43
    v_lshlrev_b32 v42, 16, v41
    v_and_b32 v43, 0xffff0000, v41
    v_add_f32 v40, v40, v42
    v_add_f32 v40, v40, v43
    s_nop 1
    v_add_f32_dpp v40, v40, v40 quad_perm:[1,0,3,2] row_mask:0xf bank_mask:0xf
    s_nop 2
    v_add_f32_dpp v40, v40, v40 quad_perm:[2,3,0,1] row_mask:0xf bank_mask:0xf
    s_nop 2
    v_add_f32_dpp v40, v40, v40 row_half_mirror row_mask:0xf bank_mask:0xf
    s_nop 2
    v_add_f32_dpp v40, v40, v40 row_mirror row_mask:0xf bank_mask:0xf
    s_nop 2
    v_mov_b32 v41, v40
    s_nop 1
    v_permlane16_swap_b32 v40, v41
    v_add_f32 v40, v40, v41
    s_nop 1
    v_mov_b32 v41, v40
    s_nop 1
    v_permlane32_swap_b32 v40, v41
    v_add_f32 v40, v40, v41
    s_nop 1
    v_cvt_pk_bf16_f32 v40, v40, v40
    v_lshlrev_b32 v40, 16, v40
    v_mul_f32 v41, 0xbfb8aa3b, v40
    v_exp_f32 v41, v41
    s_nop 0
    v_add_f32 v41, 1.0, v41
    v_rcp_f32 v41, v41
    s_nop 0
    v_cvt_pk_bf16_f32 v41, v41, v41
    v_lshlrev_b32 v41, 16, v41
    v_lshlrev_b32 v2, 2, v252
    v_add_u32 v2, 132096, v2
    ds_write_b32 v2, v41
    s_waitcnt lgkmcnt(0)
    s_barrier
    v_cmp_gt_u32 vcc, 256, v250
    s_and_saveexec_b64 s[44:45], vcc
    s_cbranch_execz L_fin
    v_lshrrev_b32 v1, 6, v250
    v_and_b32 v3, 63, v250
    v_lshlrev_b32 v2, 12, v1
    v_lshl_add_u32 v2, v3, 3, v2
    s_lshl_b32 s35, s27, 9
    s_add_u32 s35, s35, 2162688
    v_add_u32 v2, s35, v2
    s_mov_b32 s40, 0
L_spin3:
    global_load_dwordx2 v[16:17], v2, s[14:15] sc1
    v_add_u32 v2, 0x4000, v2
    global_load_dwordx2 v[18:19], v2, s[14:15] sc1
    v_add_u32 v2, 0x4000, v2
    global_load_dwordx2 v[20:21], v2, s[14:15] sc1
    v_add_u32 v2, 0x4000, v2
    global_load_dwordx2 v[22:23], v2, s[14:15] sc1
    v_add_u32 v2, 0x4000, v2
    global_load_dwordx2 v[24:25], v2, s[14:15] sc1
    v_add_u32 v2, 0x4000, v2
    global_load_dwordx2 v[26:27], v2, s[14:15] sc1
    v_add_u32 v2, 0x4000, v2
    global_load_dwordx2 v[28:29], v2, s[14:15] sc1
    v_add_u32 v2, 0x4000, v2
    global_load_dwordx2 v[30:31], v2, s[14:15] sc1
    v_add_u32 v2, 0x4000, v2
    global_load_dwordx2 v[32:33], v2, s[14:15] sc1
    v_add_u32 v2, 0x4000, v2
    global_load_dwordx2 v[34:35], v2, s[14:15] sc1
    v_add_u32 v2, 0x4000, v2
    global_load_dwordx2 v[36:37], v2, s[14:15] sc1
    v_add_u32 v2, 0x4000, v2
    global_load_dwordx2 v[38:39], v2, s[14:15] sc1
    v_add_u32 v2, 0x4000, v2
    global_load_dwordx2 v[40:41], v2, s[14:15] sc1
    v_add_u32 v2, 0x4000, v2
    global_load_dwordx2 v[42:43], v2, s[14:15] sc1
    v_add_u32 v2, 0x4000, v2
    global_load_dwordx2 v[44:45], v2, s[14:15] sc1
    v_add_u32 v2, 0x4000, v2
    global_load_dwordx2 v[46:47], v2, s[14:15] sc1
    v_add_u32 v2, 0x4000, v2
    global_load_dwordx2 v[48:49], v2, s[14:15] sc1
    v_add_u32 v2, 0x4000, v2
    global_load_dwordx2 v[50:51], v2, s[14:15] sc1
    v_add_u32 v2, 0x4000, v2
    global_load_dwordx2 v[52:53], v2, s[14:15] sc1
    v_add_u32 v2, 0x4000, v2
    global_load_dwordx2 v[54:55], v2, s[14:15] sc1
    v_add_u32 v2, 0x4000, v2
    global_load_dwordx2 v[56:57], v2, s[14:15] sc1
    v_add_u32 v2, 0x4000, v2
    global_load_dwordx2 v[58:59], v2, s[14:15] sc1
    v_add_u32 v2, 0x4000, v2
    global_load_dwordx2 v[60:61], v2, s[14:15] sc1
    v_add_u32 v2, 0x4000, v2
    global_load_dwordx2 v[62:63], v2, s[14:15] sc1
    v_add_u32 v2, 0x4000, v2
    global_load_dwordx2 v[64:65], v2, s[14:15] sc1
    v_add_u32 v2, 0x4000, v2
    global_load_dwordx2 v[66:67], v2, s[14:15] sc1
    v_add_u32 v2, 0x4000, v2
    global_load_dwordx2 v[68:69], v2, s[14:15] sc1
    v_add_u32 v2, 0x4000, v2
    global_load_dwordx2 v[70:71], v2, s[14:15] sc1
    v_add_u32 v2, 0x4000, v2
    global_load_dwordx2 v[72:73], v2, s[14:15] sc1
    v_add_u32 v2, 0x4000, v2
    global_load_dwordx2 v[74:75], v2, s[14:15] sc1
    v_add_u32 v2, 0x4000, v2
    global_load_dwordx2 v[76:77], v2, s[14:15] sc1
    v_add_u32 v2, 0x4000, v2
    global_load_dwordx2 v[78:79], v2, s[14:15] sc1
    v_add_u32 v2, 0x4000, v2
    global_load_dwordx2 v[80:81], v2, s[14:15] sc1
    v_add_u32 v2, 0x4000, v2
    global_load_dwordx2 v[82:83], v2, s[14:15] sc1
    v_add_u32 v2, 0x4000, v2
    global_load_dwordx2 v[84:85], v2, s[14:15] sc1
    v_add_u32 v2, 0x4000, v2
    global_load_dwordx2 v[86:87], v2, s[14:15] sc1
    v_add_u32 v2, 0x4000, v2
    global_load_dwordx2 v[88:89], v2, s[14:15] sc1
    v_add_u32 v2, 0x4000, v2
    global_load_dwordx2 v[90:91], v2, s[14:15] sc1
    v_add_u32 v2, 0x4000, v2
    global_load_dwordx2 v[92:93], v2, s[14:15] sc1
    v_add_u32 v2, 0x4000, v2
    global_load_dwordx2 v[94:95], v2, s[14:15] sc1
    v_add_u32 v2, 0x4000, v2
    global_load_dwordx2 v[96:97], v2, s[14:15] sc1
    v_add_u32 v2, 0x4000, v2
    global_load_dwordx2 v[98:99], v2, s[14:15] sc1
    v_add_u32 v2, 0x4000, v2
    global_load_dwordx2 v[100:101], v2, s[14:15] sc1
    v_add_u32 v2, 0x4000, v2
    global_load_dwordx2 v[102:103], v2, s[14:15] sc1
    v_add_u32 v2, 0x4000, v2
    global_load_dwordx2 v[104:105], v2, s[14:15] sc1
    v_add_u32 v2, 0x4000, v2
    global_load_dwordx2 v[106:107], v2, s[14:15] sc1
    v_subrev_u32 v2, 737280, v2
    s_waitcnt vmcnt(0)
    v_xor_b32 v207, v17, v254
    v_xor_b32 v208, v19, v254
    v_or_b32 v207, v207, v208
    v_xor_b32 v208, v21, v254
    v_or_b32 v207, v207, v208
    v_xor_b32 v208, v23, v254
    v_or_b32 v207, v207, v208
    v_xor_b32 v208, v25, v254
    v_or_b32 v207, v207, v208
    v_xor_b32 v208, v27, v254
    v_or_b32 v207, v207, v208
    v_xor_b32 v208, v29, v254
    v_or_b32 v207, v207, v208
    v_xor_b32 v208, v31, v254
    v_or_b32 v207, v207, v208
    v_xor_b32 v208, v33, v254
    v_or_b32 v207, v207, v208
    v_xor_b32 v208, v35, v254
    v_or_b32 v207, v207, v208
    v_xor_b32 v208, v37, v254
    v_or_b32 v207, v207, v208
    v_xor_b32 v208, v39, v254
    v_or_b32 v207, v207, v208
    v_xor_b32 v208, v41, v254
    v_or_b32 v207, v207, v208
    v_xor_b32 v208, v43, v254
    v_or_b32 v207, v207, v208
    v_xor_b32 v208, v45, v254
    v_or_b32 v207, v207, v208
    v_xor_b32 v208, v47, v254
    v_or_b32 v207, v207, v208
    v_xor_b32 v208, v49, v254
    v_or_b32 v207, v207, v208
    v_xor_b32 v208, v51, v254
    v_or_b32 v207, v207, v208
    v_xor_b32 v208, v53, v254
    v_or_b32 v207, v207, v208
    v_xor_b32 v208, v55, v254
    v_or_b32 v207, v207, v208
    v_xor_b32 v208, v57, v254
    v_or_b32 v207, v207, v208
    v_xor_b32 v208, v59, v254
    v_or_b32 v207, v207, v208
    v_xor_b32 v208, v61, v254
    v_or_b32 v207, v207, v208
    v_xor_b32 v208, v63, v254
    v_or_b32 v207, v207, v208
    v_xor_b32 v208, v65, v254
    v_or_b32 v207, v207, v208
    v_xor_b32 v208, v67, v254
    v_or_b32 v207, v207, v208
    v_xor_b32 v208, v69, v254
    v_or_b32 v207, v207, v208
    v_xor_b32 v208, v71, v254
    v_or_b32 v207, v207, v208
    v_xor_b32 v208, v73, v254
    v_or_b32 v207, v207, v208
    v_xor_b32 v208, v75, v254
    v_or_b32 v207, v207, v208
    v_xor_b32 v208, v77, v254
    v_or_b32 v207, v207, v208
    v_xor_b32 v208, v79, v254
    v_or_b32 v207, v207, v208
    v_xor_b32 v208, v81, v254
    v_or_b32 v207, v207, v208
    v_xor_b32 v208, v83, v254
    v_or_b32 v207, v207, v208
    v_xor_b32 v208, v85, v254
    v_or_b32 v207, v207, v208
    v_xor_b32 v208, v87, v254
    v_or_b32 v207, v207, v208
    v_xor_b32 v208, v89, v254
    v_or_b32 v207, v207, v208
    v_xor_b32 v208, v91, v254
    v_or_b32 v207, v207, v208
    v_xor_b32 v208, v93, v254
    v_or_b32 v207, v207, v208
    v_xor_b32 v208, v95, v254
    v_or_b32 v207, v207, v208
    v_xor_b32 v208, v97, v254
    v_or_b32 v207, v207, v208
    v_xor_b32 v208, v99, v254
    v_or_b32 v207, v207, v208
    v_xor_b32 v208, v101, v254
    v_or_b32 v207, v207, v208
    v_xor_b32 v208, v103, v254
    v_or_b32 v207, v207, v208
    v_xor_b32 v208, v105, v254
    v_or_b32 v207, v207, v208
    v_xor_b32 v208, v107, v254
    v_or_b32 v207, v207, v208
    v_cmp_ne_u32 vcc, 0, v207
    s_cbranch_vccz L_spind3
    s_sleep 1
    s_add_u32 s40, s40, 1
    s_cmp_lt_u32 s40, 200000
    s_cbranch_scc1 L_spin3
L_spind3:
    v_mov_b32 v4, v16
    v_add_f32 v4, v4, v18
    v_add_f32 v4, v4, v20
    v_add_f32 v4, v4, v22
    v_add_f32 v4, v4, v24
    v_add_f32 v4, v4, v26
    v_add_f32 v4, v4, v28
    v_add_f32 v4, v4, v30
    v_add_f32 v4, v4, v32
    v_add_f32 v4, v4, v34
    v_add_f32 v4, v4, v36
    v_add_f32 v4, v4, v38
    v_add_f32 v4, v4, v40
    v_add_f32 v4, v4, v42
    v_add_f32 v4, v4, v44
    v_add_f32 v4, v4, v46
    v_add_f32 v4, v4, v48
    v_add_f32 v4, v4, v50
    v_add_f32 v4, v4, v52
    v_add_f32 v4, v4, v54
    v_add_f32 v4, v4, v56
    v_add_f32 v4, v4, v58
    v_add_f32 v4, v4, v60
    v_add_f32 v4, v4, v62
    v_add_f32 v4, v4, v64
    v_add_f32 v4, v4, v66
    v_add_f32 v4, v4, v68
    v_add_f32 v4, v4, v70
    v_add_f32 v4, v4, v72
    v_add_f32 v4, v4, v74
    v_add_f32 v4, v4, v76
    v_add_f32 v4, v4, v78
    v_mov_b32 v5, v80
    v_add_f32 v5, v5, v82
    v_add_f32 v5, v5, v84
    v_add_f32 v5, v5, v86
    v_add_f32 v5, v5, v88
    v_add_f32 v5, v5, v90
    v_add_f32 v5, v5, v92
    v_add_f32 v5, v5, v94
    v_add_f32 v5, v5, v96
    v_add_f32 v5, v5, v98
    v_add_f32 v5, v5, v100
    v_add_f32 v5, v5, v102
    v_add_f32 v5, v5, v104
    v_add_f32 v5, v5, v106
    v_lshlrev_b32 v6, 2, v1
    v_add_u32 v6, 132096, v6
    ds_read_b32 v6, v6
    s_waitcnt lgkmcnt(0)
    v_cvt_pk_bf16_f32 v4, v4, v5
    v_and_b32 v5, 0xffff0000, v4
    v_lshlrev_b32 v4, 16, v4
    v_sub_f32 v7, 1.0, v6
    v_cvt_pk_bf16_f32 v7, v7, v7
    v_lshlrev_b32 v7, 16, v7
    v_mul_f32 v4, v6, v4
    v_mul_f32 v5, v7, v5
    v_cvt_pk_bf16_f32 v4, v4, v5
    v_and_b32 v5, 0xffff0000, v4
    v_lshlrev_b32 v4, 16, v4
    v_add_f32 v4, v4, v5
    v_cvt_pk_bf16_f32 v4, v4, v4
    v_lshlrev_b32 v2, 10, v1
    v_lshl_add_u32 v2, v3, 1, v2
    s_lshl_b32 s35, s27, 7
    v_add_u32 v2, s35, v2
    global_store_short v2, v4, s[24:25]
    s_cmp_lg_u32 s2, 248
    s_cbranch_scc1 L_fin
    v_cmp_eq_u32 vcc, 0, v250
    s_and_b64 exec, exec, vcc
    v_mov_b32 v2, 0
    global_store_dword v2, v254, s[14:15] sc1
L_fin:
    s_mov_b64 exec, -1
L_end2:
L_end:
    s_endpgm
.section .rodata,"a"
.p2align 6
.amdhsa_kernel gated_mix__sliding_block_cached__glu_gated_reglu__decode_kernel
  .amdhsa_next_free_vgpr 256
  .amdhsa_next_free_sgpr 102
  .amdhsa_accum_offset 256
  .amdhsa_group_segment_fixed_size 0
  .amdhsa_kernarg_size 104
  .amdhsa_user_sgpr_count 2
  .amdhsa_user_sgpr_kernarg_segment_ptr 1
  .amdhsa_system_sgpr_workgroup_id_x 1
.end_amdhsa_kernel
```
